```python
import torch

def _softmax(x, axis=-1):
    return torch.softmax(x, dim=axis)

def _gelu(x):
    return torch.nn.functional.gelu(x, approximate='tanh')

def _silu(x):
    return torch.nn.functional.silu(x)

def _sigmoid(x):
    return torch.sigmoid(x)

def _layernorm(x, axis=-1, eps=1e-05):
    m = x.mean(dim=axis, keepdim=True)
    v = x.var(dim=axis, keepdim=True, unbiased=False)
    return (x - m) / torch.sqrt(v + eps)

def _scatter_add(tgt, idx, src, axis=0):
    return tgt.clone().index_add_(axis, idx, src)

def _segment_sum(src, seg, n):
    out = torch.zeros((n,) + src.shape[1:], dtype=src.dtype)
    return out.index_add_(0, seg, src)

def _pad(x, pw):
    flat = tuple((v for pair in reversed(pw) for v in pair))
    return torch.nn.functional.pad(x, flat)
kernel_name = 'adaLN_cond__sliding_block_cached__glu_gated_swiglu__decode'

def setup_inputs():

    _w = lambda a: (lambda t: t.to(torch.bfloat16) if t.is_floating_point() else t)(torch.as_tensor(a))

    def _A_setup():
        B, Sq, D = (8, 1, 448)
        Hq, Hkv, Sk, Dh = (16, 8, 8192, 256)
        assert Hq % Hkv == 0, (Hq, Hkv)
        return {'x': _w((lambda *s: torch.randn(*s, dtype=torch.bfloat16) * 0.05)(B, Sq, D)), 'k_cache': _w((lambda *s: torch.randn(*s, dtype=torch.bfloat16) * 0.8)(B, Hkv, Sk, Dh)), 'v_cache': _w((lambda *s: torch.randn(*s, dtype=torch.bfloat16) * 3.2)(B, Hkv, Sk, Dh)), 'wq': _w((lambda *s: torch.randn(*s, dtype=torch.bfloat16) * 0.8)(D, Hq * Dh) * D ** (-0.5)), 'wo': _w((lambda *s: torch.randn(*s, dtype=torch.bfloat16) * 3.2)(Hq * Dh, D) * (Hq * Dh) ** (-0.5))}
    _A_in = _A_setup()

    def _B_setup():
        B, S, D, F = (8, 1, 448, 1792)
        return {'x': _w((lambda *s: torch.randn(*s, dtype=torch.bfloat16) * 0.05)(B, S, D)), 'w1': _w((lambda *s: torch.randn(*s, dtype=torch.bfloat16) * 1.6)(D, F) * (2.0 / D) ** 0.5), 'w3': _w((lambda *s: torch.randn(*s, dtype=torch.bfloat16) * 1.6)(D, F) * (2.0 / D) ** 0.5), 'w2': _w((lambda *s: torch.randn(*s, dtype=torch.bfloat16) * 1.6)(F, D) * (2.0 / F) ** 0.5)}
    _B_in = _B_setup()
    return {'A_x': _A_in['x'], 'A_k_cache': _A_in['k_cache'], 'A_v_cache': _A_in['v_cache'], 'A_wq': _A_in['wq'], 'A_wo': _A_in['wo'], 'B_x': _B_in['x'], 'B_w1': _B_in['w1'], 'B_w3': _B_in['w3'], 'B_w2': _B_in['w2'], 'c': _w((lambda *s: torch.randn(*s, dtype=torch.bfloat16) * 0.4)(8, 448) * 8.0), 'w_mod': _w((lambda *s: torch.randn(*s, dtype=torch.bfloat16) * 0.4)(448, 6 * 448) * 448 ** (-0.5) * 8.0)}

def reference(A_x, A_k_cache, A_v_cache, A_wq, A_wo, B_x, B_w1, B_w3, B_w2, c, w_mod):

    def _A_ref(x, k_cache, v_cache, wq, wo):
        B, Sq, D = x.shape
        Hq, Dh = (16, 256)
        Hkv, Sk = (k_cache.shape[1], k_cache.shape[2])
        W = min(4096, max(256, Sk // 4))
        rep = Hq // Hkv
        q = (lambda x, *d: x.permute(*d))((x @ wq).reshape(B, Sq, Hq, Dh), 0, 2, 1, 3)
        k = (lambda x, n, axis: torch.repeat_interleave(x, n, dim=axis))(k_cache[:, :, Sk - W:, :], rep, axis=1)
        v = (lambda x, n, axis: torch.repeat_interleave(x, n, dim=axis))(v_cache[:, :, Sk - W:, :], rep, axis=1)
        scores = torch.einsum('bhqd,bhkd->bhqk', q, k) * Dh ** (-0.5)
        p = _softmax(scores, axis=-1)
        o = torch.einsum('bhqk,bhkd->bhqd', p, v)
        return (lambda x, *d: x.permute(*d))(o, 0, 2, 1, 3).reshape(B, Sq, Hq * Dh) @ wo

    def _B_ref(x, w1, w3, w2):
        gate = torch.einsum('bsd,df->bsf', x, w1)
        up = torch.einsum('bsd,df->bsf', x, w3)
        h = _silu(gate) * up
        out = torch.einsum('bsf,fd->bsd', h, w2)
        return out
    x = A_x
    mod = (_silu(c) @ w_mod).reshape(c.shape[0], 6, 1, -1)
    sa, ca, ga, sb, cb, gb = (mod[:, 0].clone(), mod[:, 1].clone(), mod[:, 2].clone(), mod[:, 3].clone(), mod[:, 4].clone(), mod[:, 5].clone())
    h = _layernorm(x, axis=-1) * (1 + ca) + sa
    x = x + ga * _A_ref(h, A_k_cache, A_v_cache, A_wq, A_wo)
    h = _layernorm(x, axis=-1) * (1 + cb) + sb
    x = x + gb * _B_ref(h, B_w1, B_w3, B_w2)
    return x
```

```asm
; @launch grid=(256,1,1) block=(256,1,1) lds=162048
.amdgcn_target "amdgcn-amd-amdhsa--gfx950"
.text
.globl adaLN_cond__sliding_block_cached__glu_gated_swiglu__decode_kernel
.p2align 8
.type adaLN_cond__sliding_block_cached__glu_gated_swiglu__decode_kernel,@function
adaLN_cond__sliding_block_cached__glu_gated_swiglu__decode_kernel:
    s_cmp_ge_u32 s2, 256
    s_cbranch_scc1 L_end
    s_load_dwordx16 s[64:79], s[0:1], 0
    s_load_dwordx8 s[80:87], s[0:1], 64
    s_load_dwordx4 s[88:91], s[0:1], 96
    s_and_b32 s7, s2, 31
    s_lshr_b32 s61, s2, 3
    s_and_b32 s60, s61, 4
    s_xor_b32 s60, s60, s7
    s_cmp_ge_u32 s7, 24
    s_cselect_b32 s7, s60, s7
    s_cmp_ge_u32 s7, 28
    s_cbranch_scc1 L_progI
    v_lshrrev_b32 v1, 6, v0
    v_and_b32 v0, 63, v0
    v_readfirstlane_b32 s3, v1
    s_and_b32 s4, s2, 7
    s_and_b32 s5, s61, 3
    s_lshr_b32 s6, s2, 5
    s_mov_b32 s92, 0
    v_lshlrev_b32 v1, 4, v0
    s_mul_i32 s57, s3, 14336
    s_add_u32 s58, s57, 57344
    v_lshrrev_b32 v2, 5, v0
    v_xor_b32 v2, v2, v0
    v_lshlrev_b32 v2, 4, v2
    s_lshl_b32 s59, s3, 5
    v_xor_b32 v24, s59, v0
    v_and_b32 v24, 32, v24
    v_lshl_add_u32 v2, v24, 11, v2
    s_lshl3_add_u32 s59, s6, s4
    s_lshl2_add_u32 s59, s59, 3
    s_lshl_b32 s59, s59, 20
    s_lshl_b32 s60, s3, 3
    s_lshr_b32 s60, 0xcd61ac00, s60
    s_lshl_b32 s61, s5, 3
    s_lshr_b32 s61, 0x2b86ad00, s61
    s_xor_b32 s60, s60, s61
    s_and_b32 s60, s60, 0xff
    s_lshl_b32 s40, s60, 12
    s_mul_i32 s56, s3, 8448
    s_add_u32 s56, s56, 114688
    s_mov_b32 s10, 0x100000
    s_mov_b32 s11, 0x20000
    s_mov_b32 s14, 0x100000
    s_mov_b32 s15, 0x20000
    s_waitcnt lgkmcnt(0)
    s_add_u32 s8, s66, s59
    s_addc_u32 s9, s67, 0
    s_add_u32 s12, s68, s59
    s_addc_u32 s13, s69, 0
    s_mov_b32 m0, s56
    s_xor_b32 s41, s40, 0xab000
    buffer_load_dwordx4 v2, s[8:11], s40 offen offset:0 nt lds
    s_add_u32 m0, s56, 32
    s_nop 0
    buffer_load_dwordx4 v2, s[8:11], s40 offen offset:1024 nt lds
    s_add_u32 m0, s56, 64
    s_nop 0
    buffer_load_dwordx4 v2, s[8:11], s40 offen offset:2048 nt lds
    s_add_u32 m0, s56, 96
    s_nop 0
    buffer_load_dwordx4 v2, s[8:11], s40 offen offset:3072 nt lds
    s_add_u32 m0, s56, 4224
    s_xor_b32 s42, s40, 0x8000
    buffer_load_dwordx4 v2, s[8:11], s41 offen offset:0 nt lds
    s_add_u32 m0, s56, 4256
    s_nop 0
    buffer_load_dwordx4 v2, s[8:11], s41 offen offset:1024 nt lds
    s_mul_i32 s59, s5, 917504
    s_lshl_b32 s60, s4, 10
    s_add_u32 s59, s59, s60
    s_lshl_b32 s60, s6, 7
    s_add_u32 s59, s59, s60
    s_add_u32 s36, s70, s59
    s_addc_u32 s37, s71, 0
    s_mov_b32 s38, 909440
    s_mov_b32 s39, 0x20000
    v_lshrrev_b32 v24, 3, v0
    v_and_b32 v25, 7, v0
    v_lshlrev_b32 v25, 4, v25
    v_lshl_add_u32 v24, v24, 13, v25
    s_lshl_b32 s59, s3, 18
    v_add_u32 v5, s59, v24
    s_lshr_b32 s59, s6, 2
    s_lshl_b32 s59, s59, 16
    v_xor_b32 v5, s59, v5
    s_lshl_b32 s59, s6, 8
    s_and_b32 s59, s59, 1024
    s_xor_b32 s59, s59, 0
    s_add_u32 s59, s59, s57
    s_add_u32 m0, s59, 8448
    s_nop 0
    buffer_load_dwordx4 v5, s[36:39], 0 offen  lds
    v_xor_b32 v5, 0x10000, v5
    s_lshl_b32 s59, s6, 8
    s_and_b32 s59, s59, 1024
    s_xor_b32 s59, s59, 1024
    s_add_u32 s59, s59, s57
    s_add_u32 m0, s59, 8448
    s_nop 0
    buffer_load_dwordx4 v5, s[36:39], 0 offen  lds
    v_xor_b32 v5, 0x30000, v5
    s_lshl_b32 s59, s6, 8
    s_and_b32 s59, s59, 1024
    s_xor_b32 s59, s59, 2048
    s_add_u32 s59, s59, s57
    s_add_u32 m0, s59, 8448
    s_nop 0
    buffer_load_dwordx4 v5, s[36:39], 0 offen  lds
    v_xor_b32 v5, 0x10000, v5
    s_lshl_b32 s59, s6, 8
    s_and_b32 s59, s59, 1024
    s_xor_b32 s59, s59, 3072
    s_add_u32 s59, s59, s57
    s_add_u32 m0, s59, 8448
    s_nop 0
    buffer_load_dwordx4 v5, s[36:39], 0 offen  lds
    s_add_u32 s59, s4, s5
    s_add_u32 s59, s59, 1
    s_and_b32 s59, s59, 3
    s_and_b32 s7, s7, 28
    s_or_b32 s7, s7, s59
    s_lshl_b32 s59, s7, 7
    s_mul_i32 s60, s3, 401408
    s_add_u32 s59, s59, s60
    s_add_u32 s20, s76, s59
    s_addc_u32 s21, s77, 0
    s_mov_b32 s22, 397952
    s_mov_b32 s23, 0x20000
    s_add_u32 s24, s78, s59
    s_addc_u32 s25, s79, 0
    s_mov_b32 s26, 397952
    s_mov_b32 s27, 0x20000
    v_lshrrev_b32 v24, 3, v0
    v_mul_u32_u24 v24, 3584, v24
    v_and_b32 v25, 7, v0
    v_lshl_add_u32 v7, v25, 4, v24
    v_and_b32 v24, 32, v0
    v_xor_b32 v7, v7, v24
    s_sub_u32 s59, 2, s4
    s_and_b32 s59, s59, 3
    s_cmp_gt_u32 s5, s59
    s_subb_u32 s60, s5, 0
    s_lshl3_add_u32 s60, s60, s6
    s_lshr_b32 s61, s6, 1
    s_add_u32 s61, s61, 16
    s_cmp_eq_u32 s5, 3
    s_cselect_b32 s60, s61, s60
    s_lshl2_add_u32 s60, s60, s3
    s_cmp_eq_u32 s59, 3
    s_cselect_b32 s61, 38, 45
    s_cmp_eq_u32 s5, s59
    s_cselect_b32 s61, 1, s61
    s_mul_i32 s60, s60, s61
    s_sub_u32 s61, s61, 1
    v_min_u32 v24, s61, v0
    v_add_u32 v24, s60, v24
    v_min_u32 v24, 3583, v24
    s_mul_i32 s59, s4, 458752
    v_lshl_add_u32 v25, v24, 7, s59
    global_load_dword v119, v25, s[72:73]
    v_and_b32 v25, 3, v24
    s_add_u32 s59, s4, 1
    v_add_u32 v26, s59, v25
    v_and_b32 v26, 3, v26
    v_lshl_add_u32 v26, v25, 3, v26
    s_and_b32 s59, s4, 4
    v_cmp_gt_u32 vcc, 3, v25
    v_mov_b32 v25, s59
    s_nop 0
    v_cndmask_b32 v25, 0, v25, vcc
    v_add_lshl_u32 v25, v25, v26, 7
    v_lshrrev_b32 v24, 2, v24
    v_cmp_gt_u32 vcc, 448, v24
    v_add_u32 v26, -448, v24
    s_nop 0
    v_cndmask_b32 v24, v26, v24, vcc
    s_movk_i32 s59, 3584
    v_mad_u32_u24 v25, v24, s59, v25
    v_mov_b32 v26, s78
    v_mov_b32 v24, s76
    v_cndmask_b32 v26, v26, v24, vcc
    v_mov_b32 v27, s79
    v_mov_b32 v24, s77
    v_cndmask_b32 v27, v27, v24, vcc
    v_add_co_u32 v26, vcc, v26, v25
    s_nop 1
    v_addc_co_u32 v27, vcc, 0, v27, vcc
    global_load_dword v119, v[26:27], off
    s_getpc_b64 s[100:101]
L_pc_1:
    s_sub_u32 s100, s100, L_pc_1-adaLN_cond__sliding_block_cached__glu_gated_swiglu__decode_kernel
    s_subb_u32 s101, s101, 0
    s_mul_i32 s59, s6, 3
    s_add_u32 s59, s59, s5
    s_lshl2_add_u32 s59, s59, s3
    s_mul_i32 s59, s59, 384
    v_min_u32 v24, 2, v0
    v_lshl_add_u32 v24, v24, 7, s59
    v_min_u32 v24, L_codeend-adaLN_cond__sliding_block_cached__glu_gated_swiglu__decode_kernel-4, v24
    v_mov_b32 v25, s101
    v_add_co_u32 v24, vcc, s100, v24
    s_nop 1
    v_addc_co_u32 v25, vcc, 0, v25, vcc
    global_load_dword v119, v[24:25], off
    s_mov_b32 s16, s90
    s_mov_b32 s17, s91
    s_mov_b32 s18, 1572864
    s_mov_b32 s19, 0x20000
    s_load_dword s88, s[90:91], 980992
    s_lshl2_add_u32 s62, s5, s3
    s_lshl2_add_u32 s63, s2, s3
    v_mov_b32 v24, 1073741824
    s_lshl3_add_u32 s59, s4, s6
    s_lshl4_add_u32 s59, s59, s62
    s_lshl_b32 s59, s59, 9
    s_mov_b64 exec, 0xf
    v_mov_b32 v24, s59
    s_mul_i32 s59, s63, 384
    s_add_u32 s59, s59, 524288
    s_mov_b64 exec, 0x70
    v_mov_b32 v24, s59
    s_lshl3_add_u32 s59, s6, s4
    s_lshl2_add_u32 s59, s59, s5
    s_lshl_b32 s59, s59, 7
    s_add_u32 s59, s59, 917504
    s_mov_b64 exec, 0x100
    v_mov_b32 v24, s59
    s_mov_b64 exec, 0xfffff
    v_and_b32 v25, 3, v0
    v_lshl_add_u32 v24, v25, 7, v24
    buffer_load_dword v119, v24, s[16:19], 0 offen sc1
    s_mov_b64 exec, -1
    s_waitcnt vmcnt(13)
    s_add_u32 m0, s56, 4288
    s_nop 0
    buffer_load_dwordx4 v2, s[8:11], s41 offen offset:2048 nt lds
    s_waitcnt vmcnt(13)
    s_add_u32 m0, s56, 4320
    s_nop 0
    buffer_load_dwordx4 v2, s[8:11], s41 offen offset:3072 nt lds
    s_waitcnt vmcnt(13)
    s_mov_b32 m0, s57
    s_xor_b32 s43, s40, 0xa3000
    buffer_load_dwordx4 v2, s[8:11], s42 offen offset:0 nt lds
    s_waitcnt vmcnt(13)
    s_add_u32 m0, s57, 32
    s_nop 0
    buffer_load_dwordx4 v2, s[8:11], s42 offen offset:1024 nt lds
    s_add_u32 m0, s58, 0
    s_mov_b32 s60, 0
    buffer_load_dwordx4 v7, s[20:23], s60 offen  lds
    s_waitcnt vmcnt(14)
    s_add_u32 m0, s57, 64
    s_nop 0
    buffer_load_dwordx4 v2, s[8:11], s42 offen offset:2048 nt lds
    v_bfe_u32 v24, v0, 1, 1
    v_bfe_u32 v25, v0, 2, 2
    v_lshl_add_u32 v24, v24, 2, v25
    v_mul_u32_u24 v24, 1056, v24
    v_and_b32 v25, 1, v0
    v_lshl_add_u32 v24, v25, 9, v24
    v_lshrrev_b32 v26, 4, v0
    v_xor_b32 v26, v26, v25
    v_lshl_add_u32 v24, v26, 4, v24
    v_add_u32 v3, s56, v24
    v_add_u32 v4, s57, v24
    v_xor_b32 v7, 64, v7
    s_add_u32 m0, s58, 1024
    s_mov_b32 s60, 57344
    buffer_load_dwordx4 v7, s[20:23], s60 offen  lds
    s_waitcnt vmcnt(15)
    s_add_u32 m0, s57, 96
    s_nop 0
    buffer_load_dwordx4 v2, s[8:11], s42 offen offset:3072 nt lds
    s_waitcnt vmcnt(7)
    s_add_u32 m0, s57, 4224
    s_xor_b32 s44, s40, 0xe5000
    buffer_load_dwordx4 v2, s[8:11], s43 offen offset:0 nt lds
    v_bfe_u32 v24, v0, 4, 1
    v_bfe_u32 v25, v0, 3, 1
    v_lshl_add_u32 v24, v24, 2, v25
    v_lshlrev_b32 v24, 7, v24
    v_and_b32 v25, 3, v0
    v_lshl_add_u32 v24, v25, 3, v24
    v_add_u32 v24, s58, v24
    v_and_b32 v25, 16, v0
    v_lshl_add_u32 v24, v25, 1, v24
    v_and_b32 v25, 4, v0
    v_xor_b32 v25, 4, v25
    v_lshl_add_u32 v24, v25, 4, v24
    v_lshrrev_b32 v25, 5, v0
    v_bfe_u32 v26, v0, 2, 1
    v_lshl_add_u32 v25, v25, 1, v26
    v_add_u32 v26, 3, v25
    v_lshl_add_u32 v14, v26, 10, v24
    v_max_u32 v25, 1, v25
    v_add_u32 v25, -1, v25
    v_lshl_add_u32 v8, v25, 10, v24
    v_xor_b32 v7, 64, v7
    s_add_u32 m0, s58, 2048
    s_mov_b32 s60, 114688
    buffer_load_dwordx4 v7, s[20:23], s60 offen  lds
    s_waitcnt vmcnt(8)
    s_add_u32 m0, s57, 4256
    s_nop 0
    buffer_load_dwordx4 v2, s[8:11], s43 offen offset:1024 nt lds
    ds_read_b128 a[0:3], v3 offset:0
    ds_read_b128 a[4:7], v3 offset:64
    ds_read_b128 a[8:11], v3 offset:128
    ds_read_b128 a[12:15], v3 offset:192
    ds_read_b128 a[16:19], v3 offset:256
    ds_read_b128 a[20:23], v3 offset:320
    ds_read_b128 a[24:27], v3 offset:384
    ds_read_b128 a[28:31], v3 offset:448
    v_xor_b32 v7, 64, v7
    s_add_u32 m0, s58, 3072
    s_mov_b32 s60, 172032
    buffer_load_dwordx4 v7, s[20:23], s60 offen  lds
    s_waitcnt vmcnt(9)
    s_add_u32 m0, s57, 4288
    s_nop 0
    buffer_load_dwordx4 v2, s[8:11], s43 offen offset:2048 nt lds
    s_waitcnt lgkmcnt(0)
    s_waitcnt vmcnt(9)
    s_add_u32 m0, s57, 4320
    s_nop 0
    buffer_load_dwordx4 v2, s[8:11], s43 offen offset:3072 nt lds
    s_mov_b32 s94, 0x00ff00ff
    s_mov_b32 s95, s94
    s_not_b64 s[98:99], s[94:95]
    v_xor_b32 v7, 64, v7
    s_add_u32 m0, s58, 4096
    s_mov_b32 s60, 229376
    buffer_load_dwordx4 v7, s[20:23], s60 offen  lds
    s_waitcnt vmcnt(9)
    s_mov_b32 m0, s56
    s_xor_b32 s45, s40, 0x4e000
    buffer_load_dwordx4 v2, s[8:11], s44 offen offset:0 nt lds
    v_xor_b32 v7, 64, v7
    s_add_u32 m0, s58, 5120
    s_mov_b32 s60, 286720
    buffer_load_dwordx4 v7, s[20:23], s60 offen  lds
    s_waitcnt vmcnt(9)
    s_add_u32 m0, s56, 32
    s_nop 0
    buffer_load_dwordx4 v2, s[8:11], s44 offen offset:1024 nt lds
    s_waitcnt vmcnt(9)
    s_add_u32 m0, s56, 64
    s_nop 0
    buffer_load_dwordx4 v2, s[8:11], s44 offen offset:2048 nt lds
    v_xor_b32 v7, 64, v7
    s_add_u32 m0, s58, 6144
    s_mov_b32 s60, 344064
    buffer_load_dwordx4 v7, s[20:23], s60 offen  lds
    v_lshrrev_b32 v24, 4, v0
    v_bfe_u32 v25, v0, 2, 2
    v_lshl_add_u32 v24, v24, 3, v25
    v_mul_u32_u24 v24, 896, v24
    v_and_b32 v25, 3, v0
    v_lshl_add_u32 v9, v25, 3, v24
    s_mov_b64 exec, 0xff
    v_mov_b32 v6, 0xd7d20a01
    s_lshl_b64 exec, exec, 8
    v_mov_b32 v6, 0xd7d20a01
    s_lshl_b64 exec, exec, 8
    v_mov_b32 v6, 0xf7d28a01
    s_lshl_b64 exec, exec, 8
    v_mov_b32 v6, 0xf7d28a01
    s_lshl_b64 exec, exec, 8
    v_mov_b32 v6, 0xf5d28201
    s_lshl_b64 exec, exec, 8
    v_mov_b32 v6, 0xf5d28201
    s_lshl_b64 exec, exec, 8
    v_mov_b32 v6, 0xf5f28281
    s_lshl_b64 exec, exec, 8
    v_mov_b32 v6, 0xf5f28281
    s_mov_b64 exec, -1
    v_bfe_u32 v24, v0, 3, 1
    v_lshrrev_b32 v25, 4, v0
    v_lshlrev_b32 v25, 6, v25
    v_lshl_add_u32 v24, v24, 8, v25
    v_and_b32 v25, 7, v0
    v_lshl_add_u32 v24, v25, 3, v24
    v_add_u32 v15, 157696, v24
    s_lshl2_add_u32 s59, s6, s3
    s_lshl_b32 s59, s59, 13
    v_add_u32 v13, s59, v1
    s_waitcnt vmcnt(9)
    s_add_u32 m0, s56, 96
    s_nop 0
    buffer_load_dwordx4 v2, s[8:11], s44 offen offset:3072 nt lds
    s_add_u32 m0, s58, 7168
    s_mov_b32 s60, 0
    buffer_load_dwordx4 v7, s[24:27], s60 offen  lds
    s_lshl_b32 s59, s4, 9
    s_lshl_b32 s60, s5, 6
    s_add_u32 s59, s59, s60
    s_mul_i32 s59, s59, 896
    s_add_u32 s59, s59, s57
    s_add_u32 s28, s72, s59
    s_addc_u32 s29, s73, 0
    s_mov_b32 s30, 243712
    s_mov_b32 s31, 0x20000
    s_waitcnt vmcnt(9)
    s_add_u32 m0, s56, 4224
    s_xor_b32 s46, s40, 0xed000
    buffer_load_dwordx4 v2, s[8:11], s45 offen offset:0 nt lds
    s_waitcnt lgkmcnt(0)
    s_and_b32 s59, s88, 0x7f7f7f7f
    s_add_u32 s59, s59, 0x01010101
    s_and_b32 s88, s88, 0x80808080
    s_xor_b32 s88, s88, s59
    s_and_b32 s89, s88, 0xffff
    s_lshr_b32 s1, s88, 16
    s_waitcnt vmcnt(9)
    s_add_u32 m0, s56, 4256
    s_nop 0
    buffer_load_dwordx4 v2, s[8:11], s45 offen offset:1024 nt lds
    ds_read_b128 a[32:35], v4 offset:0
    ds_read_b128 a[36:39], v4 offset:64
    ds_read_b128 a[40:43], v4 offset:128
    ds_read_b128 a[44:47], v4 offset:192
    ds_read_b128 a[48:51], v4 offset:256
    ds_read_b128 a[52:55], v4 offset:320
    ds_read_b128 a[56:59], v4 offset:384
    ds_read_b128 a[60:63], v4 offset:448
    v_xor_b32 v7, 64, v7
    s_add_u32 m0, s58, 8192
    s_mov_b32 s60, 57344
    buffer_load_dwordx4 v7, s[24:27], s60 offen  lds
    s_waitcnt vmcnt(9)
    s_add_u32 m0, s56, 4288
    s_nop 0
    buffer_load_dwordx4 v2, s[8:11], s45 offen offset:2048 nt lds
    s_waitcnt lgkmcnt(0)
    v_xor_b32 v7, 64, v7
    s_add_u32 m0, s58, 9216
    s_mov_b32 s60, 114688
    buffer_load_dwordx4 v7, s[24:27], s60 offen  lds
    s_waitcnt vmcnt(9)
    s_add_u32 m0, s56, 4320
    s_nop 0
    buffer_load_dwordx4 v2, s[8:11], s45 offen offset:3072 nt lds
    s_waitcnt vmcnt(9)
    s_mov_b32 m0, s57
    s_xor_b32 s47, s40, 0x46000
    buffer_load_dwordx4 v2, s[8:11], s46 offen offset:0 nt lds
    v_and_b32 v24, 1, v0
    v_lshlrev_b32 v24, 4, v24
    v_mov_b32 v25, 0xffff
    v_lshlrev_b32 v24, v24, v25
    v_and_b32 v25, 2, v0
    v_cmp_eq_u32 vcc, 0, v25
    s_nop 1
    v_cndmask_b32 v10, 0, v24, vcc
    v_cndmask_b32 v11, v24, 0, vcc
    v_bfe_u32 v24, v0, 4, 1
    v_and_b32 v25, 7, v0
    v_lshlrev_b32 v25, 5, v25
    v_lshl_add_u32 v24, v24, 8, v25
    v_lshrrev_b32 v25, 5, v0
    v_lshl_add_u32 v12, v25, 4, v24
    v_xor_b32 v7, 64, v7
    s_add_u32 m0, s58, 10240
    s_mov_b32 s60, 172032
    buffer_load_dwordx4 v7, s[24:27], s60 offen  lds
    s_waitcnt vmcnt(9)
    s_add_u32 m0, s57, 32
    s_nop 0
    buffer_load_dwordx4 v2, s[8:11], s46 offen offset:1024 nt lds
    v_xor_b32 v26, 0, v8
    ds_read_b64_tr_b16 v[128:129], v26 offset:0
    ds_read_b64_tr_b16 v[130:131], v26 offset:256
    v_xor_b32 v27, 0, v14
    ds_read_b64_tr_b16 v[132:133], v27 offset:0
    ds_read_b64_tr_b16 v[134:135], v27 offset:256
    v_xor_b32 v26, 32, v8
    ds_read_b64_tr_b16 v[144:145], v26 offset:0
    ds_read_b64_tr_b16 v[146:147], v26 offset:256
    v_xor_b32 v27, 32, v14
    ds_read_b64_tr_b16 v[148:149], v27 offset:0
    ds_read_b64_tr_b16 v[150:151], v27 offset:256
    v_xor_b32 v7, 64, v7
    s_add_u32 m0, s58, 11264
    s_mov_b32 s60, 229376
    buffer_load_dwordx4 v7, s[24:27], s60 offen  lds
    s_waitcnt vmcnt(9)
    s_add_u32 m0, s57, 64
    s_nop 0
    buffer_load_dwordx4 v2, s[8:11], s46 offen offset:2048 nt lds
    v_xor_b32 v26, 64, v8
    ds_read_b64_tr_b16 v[160:161], v26 offset:0
    ds_read_b64_tr_b16 v[162:163], v26 offset:256
    v_xor_b32 v27, 64, v14
    ds_read_b64_tr_b16 v[164:165], v27 offset:0
    ds_read_b64_tr_b16 v[166:167], v27 offset:256
    v_xor_b32 v26, 96, v8
    ds_read_b64_tr_b16 v[176:177], v26 offset:0
    ds_read_b64_tr_b16 v[178:179], v26 offset:256
    v_xor_b32 v27, 96, v14
    ds_read_b64_tr_b16 v[180:181], v27 offset:0
    ds_read_b64_tr_b16 v[182:183], v27 offset:256
    s_waitcnt vmcnt(9)
    s_add_u32 m0, s57, 96
    s_nop 0
    buffer_load_dwordx4 v2, s[8:11], s46 offen offset:3072 nt lds
    s_waitcnt lgkmcnt(0)
    v_xor_b32 v7, 64, v7
    s_add_u32 m0, s58, 12288
    s_mov_b32 s60, 286720
    buffer_load_dwordx4 v7, s[24:27], s60 offen  lds
    s_waitcnt vmcnt(9)
    s_add_u32 m0, s57, 4224
    s_xor_b32 s48, s40, 0x8d000
    buffer_load_dwordx4 v2, s[8:11], s47 offen offset:0 nt lds
    v_xor_b32 v7, 64, v7
    s_add_u32 m0, s58, 13312
    s_mov_b32 s60, 344064
    buffer_load_dwordx4 v7, s[24:27], s60 offen  lds
    s_waitcnt vmcnt(9)
    s_add_u32 m0, s57, 4256
    s_nop 0
    buffer_load_dwordx4 v2, s[8:11], s47 offen offset:1024 nt lds
    ds_read_b128 a[64:67], v3 offset:0
    ds_read_b128 a[68:71], v3 offset:64
    ds_read_b128 a[72:75], v3 offset:128
    ds_read_b128 a[76:79], v3 offset:192
    ds_read_b128 a[80:83], v3 offset:256
    ds_read_b128 a[84:87], v3 offset:320
    ds_read_b128 a[88:91], v3 offset:384
    ds_read_b128 a[92:95], v3 offset:448
    s_waitcnt vmcnt(9)
    s_add_u32 m0, s57, 4288
    s_nop 0
    buffer_load_dwordx4 v2, s[8:11], s47 offen offset:2048 nt lds
    s_waitcnt lgkmcnt(0)
    s_add_u32 m0, s58, 0
    s_mov_b32 s60, 28672
    buffer_load_dwordx4 v7, s[20:23], s60 offen  lds
    s_waitcnt vmcnt(9)
    s_add_u32 m0, s57, 4320
    s_nop 0
    buffer_load_dwordx4 v2, s[8:11], s47 offen offset:3072 nt lds
    s_waitcnt vmcnt(8)
    s_mov_b32 m0, s56
    s_xor_b32 s49, s40, 0x26000
    buffer_load_dwordx4 v2, s[8:11], s48 offen offset:0 nt lds
    v_xor_b32 v7, 64, v7
    s_add_u32 m0, s58, 1024
    s_mov_b32 s60, 86016
    buffer_load_dwordx4 v7, s[20:23], s60 offen  lds
    s_waitcnt vmcnt(9)
    s_add_u32 m0, s56, 32
    s_nop 0
    buffer_load_dwordx4 v2, s[8:11], s48 offen offset:1024 nt lds
    v_xor_b32 v7, 64, v7
    s_add_u32 m0, s58, 2048
    s_mov_b32 s60, 143360
    buffer_load_dwordx4 v7, s[20:23], s60 offen  lds
    s_waitcnt vmcnt(9)
    s_add_u32 m0, s56, 64
    s_nop 0
    buffer_load_dwordx4 v2, s[8:11], s48 offen offset:2048 nt lds
    s_lshl2_add_u32 s59, s5, s3
    s_mul_i32 s59, s59, 896
    s_add_u32 s59, s59, 950272
    v_min_u32 v90, 55, v0
    v_lshl_add_u32 v88, v90, 4, s59
    v_add_u32 v89, 14336, v88
    s_mul_i32 s60, s3, 448
    s_add_u32 s60, s60, 148480
    v_lshl_add_u32 v90, v90, 3, s60
    buffer_load_dwordx4 v[80:83], v88, s[16:19], 0 offen sc1
    buffer_load_dwordx4 v[84:87], v89, s[16:19], 0 offen sc1
    s_waitcnt vmcnt(10)
    s_add_u32 m0, s56, 96
    s_nop 0
    buffer_load_dwordx4 v2, s[8:11], s48 offen offset:3072 nt lds
    v_xor_b32 v26, 0, v8
    ds_read_b64_tr_b16 v[192:193], v26 offset:7168
    ds_read_b64_tr_b16 v[194:195], v26 offset:7424
    v_xor_b32 v27, 0, v14
    ds_read_b64_tr_b16 v[196:197], v27 offset:7168
    ds_read_b64_tr_b16 v[198:199], v27 offset:7424
    v_xor_b32 v26, 32, v8
    ds_read_b64_tr_b16 v[208:209], v26 offset:7168
    ds_read_b64_tr_b16 v[210:211], v26 offset:7424
    v_xor_b32 v27, 32, v14
    ds_read_b64_tr_b16 v[212:213], v27 offset:7168
    ds_read_b64_tr_b16 v[214:215], v27 offset:7424
    v_xor_b32 v7, 64, v7
    s_add_u32 m0, s58, 3072
    s_mov_b32 s60, 200704
    buffer_load_dwordx4 v7, s[20:23], s60 offen  lds
    s_waitcnt vmcnt(11)
    s_add_u32 m0, s56, 4224
    s_xor_b32 s50, s40, 0x85000
    buffer_load_dwordx4 v2, s[8:11], s49 offen offset:0 nt lds
    v_xor_b32 v26, 64, v8
    ds_read_b64_tr_b16 v[224:225], v26 offset:7168
    ds_read_b64_tr_b16 v[226:227], v26 offset:7424
    v_xor_b32 v27, 64, v14
    ds_read_b64_tr_b16 v[228:229], v27 offset:7168
    ds_read_b64_tr_b16 v[230:231], v27 offset:7424
    v_xor_b32 v26, 96, v8
    ds_read_b64_tr_b16 v[240:241], v26 offset:7168
    ds_read_b64_tr_b16 v[242:243], v26 offset:7424
    v_xor_b32 v27, 96, v14
    ds_read_b64_tr_b16 v[244:245], v27 offset:7168
    ds_read_b64_tr_b16 v[246:247], v27 offset:7424
    v_xor_b32 v7, 64, v7
    s_add_u32 m0, s58, 4096
    s_mov_b32 s60, 258048
    buffer_load_dwordx4 v7, s[20:23], s60 offen  lds
    s_waitcnt vmcnt(11)
    s_add_u32 m0, s56, 4256
    s_nop 0
    buffer_load_dwordx4 v2, s[8:11], s49 offen offset:1024 nt lds
    ds_read_b128 a[96:99], v4 offset:0
    ds_read_b128 a[100:103], v4 offset:64
    ds_read_b128 a[104:107], v4 offset:128
    ds_read_b128 a[108:111], v4 offset:192
    ds_read_b128 a[112:115], v4 offset:256
    ds_read_b128 a[116:119], v4 offset:320
    ds_read_b128 a[120:123], v4 offset:384
    ds_read_b128 a[124:127], v4 offset:448
    s_waitcnt lgkmcnt(0)
    s_waitcnt vmcnt(11)
    s_add_u32 m0, s56, 4288
    s_nop 0
    buffer_load_dwordx4 v2, s[8:11], s49 offen offset:2048 nt lds
    s_waitcnt lgkmcnt(0)
    v_xor_b32 v7, 64, v7
    s_add_u32 m0, s58, 5120
    s_mov_b32 s60, 315392
    buffer_load_dwordx4 v7, s[20:23], s60 offen  lds
    s_waitcnt vmcnt(11)
    s_add_u32 m0, s56, 4320
    s_nop 0
    buffer_load_dwordx4 v2, s[8:11], s49 offen offset:3072 nt lds
    v_xor_b32 v7, 64, v7
    s_add_u32 m0, s58, 6144
    s_mov_b32 s60, 372736
    buffer_load_dwordx4 v7, s[20:23], s60 offen  lds
    s_waitcnt vmcnt(11)
    s_mov_b32 m0, s57
    s_xor_b32 s51, s40, 0x2e000
    buffer_load_dwordx4 v2, s[8:11], s50 offen offset:0 nt lds
    s_waitcnt vmcnt(9)
    s_add_u32 m0, s57, 32
    s_nop 0
    buffer_load_dwordx4 v2, s[8:11], s50 offen offset:1024 nt lds
    s_add_u32 m0, s58, 7168
    s_mov_b32 s60, 28672
    buffer_load_dwordx4 v7, s[24:27], s60 offen  lds
L_h_chk_2:
    v_xor_b32 v80, s89, v80
    v_xor_b32 v81, s1, v81
    v_xor_b32 v82, s89, v82
    v_xor_b32 v83, s1, v83
    v_xor_b32 v84, s89, v84
    v_xor_b32 v85, s1, v85
    v_xor_b32 v86, s89, v86
    v_xor_b32 v87, s1, v87
    v_or3_b32 v91, v80, v81, v82
    v_or3_b32 v91, v91, v83, v84
    v_or3_b32 v91, v91, v85, v86
    v_or_b32 v91, v91, v87
    v_and_b32 v91, 0xffff, v91
    v_cmp_ne_u32 vcc, 0, v91
    s_cbranch_vccz L_h_ok_3
    buffer_load_dwordx4 v[80:83], v88, s[16:19], 0 offen sc1
    buffer_load_dwordx4 v[84:87], v89, s[16:19], 0 offen sc1
    s_add_u32 s92, s92, 1
    s_cmp_gt_u32 s92, 1048576
    s_cbranch_scc1 L_h_giveup_4
    s_and_b32 s63, s92, 63
    s_cbranch_scc1 L_nowb_5
    s_waitcnt vmcnt(0)
    buffer_wbl2 sc1
L_nowb_5:
    s_waitcnt vmcnt(0)
    s_branch L_h_chk_2
L_h_giveup_4:
    s_waitcnt vmcnt(0)
L_h_ok_3:
    v_add_f32 v80, v80, v84
    v_add_f32 v81, v81, v85
    v_add_f32 v82, v82, v86
    v_add_f32 v83, v83, v87
    v_cvt_pk_bf16_f32 v80, v80, v81
    v_cvt_pk_bf16_f32 v81, v82, v83
    ds_write_b64 v90, v[80:81]
    v_lshrrev_b32 v96, 2, v0
    v_and_b32 v97, 3, v0
    v_lshlrev_b32 v97, 3, v97
    v_lshl_add_u32 v96, v96, 7, v97
    s_lshl_b32 s59, s3, 5
    v_add_u32 v96, s59, v96
    v_lshrrev_b32 v97, 4, v0
    v_and_b32 v26, 7, v0
    v_lshlrev_b32 v26, 3, v26
    v_lshl_add_u32 v97, v97, 6, v26
    v_add_u32 v97, 148480, v97
    s_waitcnt vmcnt(9)
    s_add_u32 m0, s57, 64
    s_nop 0
    buffer_load_dwordx4 v2, s[8:11], s50 offen offset:2048 nt lds
    v_xor_b32 v7, 64, v7
    s_add_u32 m0, s58, 8192
    s_mov_b32 s60, 86016
    buffer_load_dwordx4 v7, s[24:27], s60 offen  lds
    s_waitcnt lgkmcnt(0)
    s_barrier
    ds_read_b64_tr_b16 v[32:33], v96 offset:8448
    ds_read_b64 v[48:49], v97 offset:0
    ds_read_b64_tr_b16 v[34:35], v96 offset:10496
    ds_read_b64 v[50:51], v97 offset:256
    ds_read_b64_tr_b16 v[36:37], v96 offset:22784
    ds_read_b64 v[52:53], v97 offset:512
    ds_read_b64_tr_b16 v[38:39], v96 offset:24832
    ds_read_b64 v[54:55], v97 offset:768
    ds_read_b64_tr_b16 v[40:41], v96 offset:37120
    ds_read_b64 v[56:57], v97 offset:1024
    ds_read_b64_tr_b16 v[42:43], v96 offset:39168
    ds_read_b64 v[58:59], v97 offset:1280
    ds_read_b64_tr_b16 v[44:45], v96 offset:51456
    ds_read_b64 v[60:61], v97 offset:1536
    s_waitcnt vmcnt(9)
    s_add_u32 m0, s57, 96
    s_nop 0
    buffer_load_dwordx4 v2, s[8:11], s50 offen offset:3072 nt lds
    s_waitcnt lgkmcnt(0)
    v_mfma_f32_16x16x32_bf16 v[80:83], v[48:51], v[32:35], 0
    v_mfma_f32_16x16x32_bf16 v[80:83], v[52:55], v[36:39], v[80:83]
    v_mfma_f32_16x16x32_bf16 v[80:83], v[56:59], v[40:43], v[80:83]
    s_lshl_b32 s59, s4, 16
    s_lshl_b32 s60, s5, 11
    s_add_u32 s59, s59, s60
    s_lshl2_add_u32 s60, s6, s3
    s_lshl_b32 s60, s60, 6
    s_add_u32 s59, s59, s60
    s_add_u32 s60, s59, 0x2000
    v_mfma_f32_16x16x16_bf16 v[80:83], v[60:61], v[44:45], v[80:83]
    v_and_b32 v26, 16, v0
    v_lshlrev_b32 v26, 11, v26
    v_and_b32 v27, 32, v0
    v_lshl_add_u32 v26, v27, 9, v26
    v_and_b32 v27, 15, v0
    v_lshl_add_u32 v26, v27, 2, v26
    v_lshlrev_b32 v27, 1, v27
    v_lshrrev_b32 v27, v27, s88
    v_cmp_lt_u32 vcc, 31, v0
    s_nop 1
    v_cndmask_b32 v80, v80, v82, vcc
    v_bfi_b32 v80, 3, v27, v80
    v_cndmask_b32 v81, v81, v83, vcc
    v_bfi_b32 v81, 3, v27, v81
    buffer_store_dword v80, v26, s[16:19], s59 offen offset:0
    buffer_store_dword v81, v26, s[16:19], s60 offen offset:0
    s_waitcnt vmcnt(11)
    s_add_u32 m0, s57, 4224
    s_xor_b32 s52, s40, 0x68000
    buffer_load_dwordx4 v2, s[8:11], s51 offen offset:0 nt lds
    v_xor_b32 v7, 64, v7
    s_add_u32 m0, s58, 9216
    s_mov_b32 s60, 143360
    buffer_load_dwordx4 v7, s[24:27], s60 offen  lds
    s_waitcnt vmcnt(11)
    s_add_u32 m0, s57, 4256
    s_nop 0
    buffer_load_dwordx4 v2, s[8:11], s51 offen offset:1024 nt lds
    ds_read_b128 a[128:131], v3 offset:0
    ds_read_b128 a[132:135], v3 offset:64
    ds_read_b128 a[136:139], v3 offset:128
    ds_read_b128 a[140:143], v3 offset:192
    ds_read_b128 a[144:147], v3 offset:256
    ds_read_b128 a[148:151], v3 offset:320
    ds_read_b128 a[152:155], v3 offset:384
    ds_read_b128 a[156:159], v3 offset:448
    v_xor_b32 v7, 64, v7
    s_add_u32 m0, s58, 10240
    s_mov_b32 s60, 200704
    buffer_load_dwordx4 v7, s[24:27], s60 offen  lds
    s_waitcnt vmcnt(11)
    s_add_u32 m0, s57, 4288
    s_nop 0
    buffer_load_dwordx4 v2, s[8:11], s51 offen offset:2048 nt lds
    s_waitcnt lgkmcnt(0)
    v_xor_b32 v26, 0, v8
    ds_read_b64_tr_b16 v[136:137], v26 offset:0
    ds_read_b64_tr_b16 v[138:139], v26 offset:256
    v_xor_b32 v27, 0, v14
    ds_read_b64_tr_b16 v[140:141], v27 offset:0
    ds_read_b64_tr_b16 v[142:143], v27 offset:256
    v_xor_b32 v26, 32, v8
    ds_read_b64_tr_b16 v[152:153], v26 offset:0
    ds_read_b64_tr_b16 v[154:155], v26 offset:256
    v_xor_b32 v27, 32, v14
    ds_read_b64_tr_b16 v[156:157], v27 offset:0
    ds_read_b64_tr_b16 v[158:159], v27 offset:256
    s_waitcnt vmcnt(11)
    s_add_u32 m0, s57, 4320
    s_nop 0
    buffer_load_dwordx4 v2, s[8:11], s51 offen offset:3072 nt lds
    v_xor_b32 v26, 64, v8
    ds_read_b64_tr_b16 v[168:169], v26 offset:0
    ds_read_b64_tr_b16 v[170:171], v26 offset:256
    v_xor_b32 v27, 64, v14
    ds_read_b64_tr_b16 v[172:173], v27 offset:0
    ds_read_b64_tr_b16 v[174:175], v27 offset:256
    v_xor_b32 v26, 96, v8
    ds_read_b64_tr_b16 v[184:185], v26 offset:0
    ds_read_b64_tr_b16 v[186:187], v26 offset:256
    v_xor_b32 v27, 96, v14
    ds_read_b64_tr_b16 v[188:189], v27 offset:0
    ds_read_b64_tr_b16 v[190:191], v27 offset:256
    v_xor_b32 v7, 64, v7
    s_add_u32 m0, s58, 11264
    s_mov_b32 s60, 258048
    buffer_load_dwordx4 v7, s[24:27], s60 offen  lds
    s_waitcnt vmcnt(11)
    s_mov_b32 m0, s56
    s_xor_b32 s53, s40, 0xc3000
    buffer_load_dwordx4 v2, s[8:11], s52 offen offset:0 nt lds
    s_waitcnt lgkmcnt(0)
    v_xor_b32 v7, 64, v7
    s_add_u32 m0, s58, 12288
    s_mov_b32 s60, 315392
    buffer_load_dwordx4 v7, s[24:27], s60 offen  lds
    s_waitcnt vmcnt(11)
    s_add_u32 m0, s56, 32
    s_nop 0
    buffer_load_dwordx4 v2, s[8:11], s52 offen offset:1024 nt lds
    s_waitcnt vmcnt(9)
    s_add_u32 m0, s56, 64
    s_nop 0
    buffer_load_dwordx4 v2, s[8:11], s52 offen offset:2048 nt lds
    v_xor_b32 v7, 64, v7
    s_add_u32 m0, s58, 13312
    s_mov_b32 s60, 372736
    buffer_load_dwordx4 v7, s[24:27], s60 offen  lds
    s_waitcnt vmcnt(9)
    s_add_u32 m0, s56, 96
    s_nop 0
    buffer_load_dwordx4 v2, s[8:11], s52 offen offset:3072 nt lds
    s_waitcnt vmcnt(8)
    s_add_u32 m0, s56, 4224
    s_xor_b32 s54, s40, 0x60000
    buffer_load_dwordx4 v2, s[8:11], s53 offen offset:0 nt lds
    s_lshl_b32 s59, s4, 16
    s_lshl_b32 s60, s6, 13
    s_add_u32 s59, s59, s60
    s_lshl_b32 s60, s3, 9
    s_add_u32 s59, s59, s60
    v_lshrrev_b32 v92, 5, v0
    v_lshlrev_b32 v92, 11, v92
    v_and_b32 v93, 31, v0
    v_lshlrev_b32 v93, 4, v93
    v_add3_u32 v92, v92, v93, s59
    v_add_u32 v93, 0x1000, v92
    buffer_load_dwordx4 v[84:87], v92, s[16:19], 0 offen sc1
    buffer_load_dwordx4 v[88:91], v93, s[16:19], 0 offen sc1
    s_mul_i32 s36, s3, 224
    s_movk_i32 s37, 0x60
    v_alignbit_b32 v26, v6, v6, 0
    s_add_u32 m0, s58, 0
    s_mov_b32 s60, 0
    v_bitop3_b32 v26, v1, v26, s37 bitop3:0x78
    buffer_load_dwordx4 v26, s[28:31], s60 offen  lds
    s_waitcnt vmcnt(11)
    s_add_u32 m0, s56, 4256
    s_nop 0
    buffer_load_dwordx4 v2, s[8:11], s53 offen offset:1024 nt lds
    ds_read_b128 a[160:163], v4 offset:0
    ds_read_b128 a[164:167], v4 offset:64
    ds_read_b128 a[168:171], v4 offset:128
    ds_read_b128 a[172:175], v4 offset:192
    ds_read_b128 a[176:179], v4 offset:256
    ds_read_b128 a[180:183], v4 offset:320
    ds_read_b128 a[184:187], v4 offset:384
    ds_read_b128 a[188:191], v4 offset:448
    s_waitcnt vmcnt(10)
    s_add_u32 m0, s56, 4288
    s_nop 0
    buffer_load_dwordx4 v2, s[8:11], s53 offen offset:2048 nt lds
    s_waitcnt lgkmcnt(0)
    v_alignbit_b32 v26, v6, v6, 2
    s_add_u32 m0, s58, 1024
    s_mov_b32 s60, 1024
    v_bitop3_b32 v26, v1, v26, s37 bitop3:0x78
    buffer_load_dwordx4 v26, s[28:31], s60 offen  lds
    s_waitcnt vmcnt(10)
    s_add_u32 m0, s56, 4320
    s_nop 0
    buffer_load_dwordx4 v2, s[8:11], s53 offen offset:3072 nt lds
    s_waitcnt vmcnt(10)
    s_mov_b32 m0, s57
    s_xor_b32 s55, s40, 0xcb000
    buffer_load_dwordx4 v2, s[8:11], s54 offen offset:0 nt lds
    v_alignbit_b32 v26, v6, v6, 4
    s_add_u32 m0, s58, 2048
    s_mov_b32 s60, 2048
    v_bitop3_b32 v26, v1, v26, s37 bitop3:0x78
    buffer_load_dwordx4 v26, s[28:31], s60 offen  lds
    s_waitcnt vmcnt(10)
    s_add_u32 m0, s57, 32
    s_nop 0
    buffer_load_dwordx4 v2, s[8:11], s54 offen offset:1024 nt lds
    v_xor_b32 v26, 0, v8
    ds_read_b64_tr_b16 v[200:201], v26 offset:7168
    ds_read_b64_tr_b16 v[202:203], v26 offset:7424
    v_xor_b32 v27, 0, v14
    ds_read_b64_tr_b16 v[204:205], v27 offset:7168
    ds_read_b64_tr_b16 v[206:207], v27 offset:7424
    v_xor_b32 v26, 32, v8
    ds_read_b64_tr_b16 v[216:217], v26 offset:7168
    ds_read_b64_tr_b16 v[218:219], v26 offset:7424
    v_xor_b32 v27, 32, v14
    ds_read_b64_tr_b16 v[220:221], v27 offset:7168
    ds_read_b64_tr_b16 v[222:223], v27 offset:7424
    s_waitcnt vmcnt(10)
    s_add_u32 m0, s57, 64
    s_nop 0
    buffer_load_dwordx4 v2, s[8:11], s54 offen offset:2048 nt lds
    v_xor_b32 v26, 64, v8
    ds_read_b64_tr_b16 v[232:233], v26 offset:7168
    ds_read_b64_tr_b16 v[234:235], v26 offset:7424
    v_xor_b32 v27, 64, v14
    ds_read_b64_tr_b16 v[236:237], v27 offset:7168
    ds_read_b64_tr_b16 v[238:239], v27 offset:7424
    v_xor_b32 v26, 96, v8
    ds_read_b64_tr_b16 v[248:249], v26 offset:7168
    ds_read_b64_tr_b16 v[250:251], v26 offset:7424
    v_xor_b32 v27, 96, v14
    ds_read_b64_tr_b16 v[252:253], v27 offset:7168
    ds_read_b64_tr_b16 v[254:255], v27 offset:7424
    v_and_b32 v27, 3, v0
    v_lshlrev_b32 v27, 3, v27
    v_lshrrev_b32 v31, v27, s88
    v_bfe_u32 v28, v31, 0, 2
    v_bfe_u32 v29, v31, 2, 2
    v_bfe_u32 v30, v31, 4, 2
    v_bfe_u32 v31, v31, 6, 2
    v_and_b32 v96, 31, v0
    v_lshrrev_b32 v97, 5, v0
    v_lshlrev_b32 v97, 2, v97
    v_lshl_add_u32 v96, v96, 3, v97
    s_lshl_b32 s59, s3, 8
    s_add_u32 s59, s59, 150528
    v_add_u32 v96, s59, v96
    v_bfe_u32 v27, v0, 2, 1
    v_and_b32 v97, 48, v0
    v_lshl_add_u32 v97, v27, 9, v97
    v_add_u32 v97, 150528, v97
    v_alignbit_b32 v26, v6, v6, 6
    s_add_u32 m0, s58, 3072
    s_mov_b32 s60, 3072
    v_bitop3_b32 v26, v1, v26, s37 bitop3:0x78
    buffer_load_dwordx4 v26, s[28:31], s60 offen  lds
    s_waitcnt vmcnt(8)
    s_add_u32 m0, s57, 96
    s_nop 0
    buffer_load_dwordx4 v2, s[8:11], s54 offen offset:3072 nt lds
    s_waitcnt lgkmcnt(0)
L_q_chk_6:
    v_xor_b32 v84, v28, v84
    v_xor_b32 v85, v29, v85
    v_xor_b32 v86, v30, v86
    v_xor_b32 v87, v31, v87
    v_xor_b32 v88, v28, v88
    v_xor_b32 v89, v29, v89
    v_xor_b32 v90, v30, v90
    v_xor_b32 v91, v31, v91
    v_or3_b32 v94, v84, v85, v86
    v_or3_b32 v94, v94, v87, v88
    v_or3_b32 v94, v94, v89, v90
    v_or_b32 v94, v94, v91
    v_and_b32 v94, 3, v94
    v_cmp_ne_u32 vcc, 0, v94
    s_cbranch_vccz L_q_ok_7
    buffer_load_dwordx4 v[84:87], v92, s[16:19], 0 offen sc1
    buffer_load_dwordx4 v[88:91], v93, s[16:19], 0 offen sc1
    s_add_u32 s92, s92, 1
    s_cmp_gt_u32 s92, 1048576
    s_cbranch_scc1 L_q_giveup_8
    s_and_b32 s63, s92, 63
    s_cbranch_scc1 L_nowb_9
    s_waitcnt vmcnt(0)
    buffer_wbl2 sc1
L_nowb_9:
    s_waitcnt vmcnt(0)
    s_branch L_q_chk_6
L_q_giveup_8:
    s_waitcnt vmcnt(0)
L_q_ok_7:
    v_add_f32 v84, v84, v88
    v_add_f32 v85, v85, v89
    v_add_f32 v86, v86, v90
    v_add_f32 v87, v87, v91
    s_nop 0
    v_permlane32_swap_b32 v84, v86
    v_permlane32_swap_b32 v85, v87
    v_add_f32 v84, v84, v86
    v_add_f32 v85, v85, v87
    v_cvt_pk_bf16_f32 v84, v84, v85
    ds_write_b32 v96, v84
    s_waitcnt vmcnt(8)
    s_add_u32 m0, s57, 4224
    s_nop 0
    buffer_load_dwordx4 v2, s[8:11], s55 offen offset:0 nt lds
    s_waitcnt lgkmcnt(0)
    s_barrier
    ds_read_b128 v[32:35], v97 offset:0
    ds_read_b128 v[36:39], v97 offset:64
    ds_read_b128 v[40:43], v97 offset:128
    ds_read_b128 v[44:47], v97 offset:192
    ds_read_b128 v[48:51], v97 offset:256
    ds_read_b128 v[52:55], v97 offset:320
    ds_read_b128 v[56:59], v97 offset:384
    ds_read_b128 v[60:63], v97 offset:448
    v_alignbit_b32 v26, v6, v6, 8
    s_add_u32 m0, s58, 4096
    s_mov_b32 s60, 4096
    v_bitop3_b32 v26, v1, v26, s37 bitop3:0x78
    buffer_load_dwordx4 v26, s[28:31], s60 offen  lds
    s_waitcnt vmcnt(8)
    s_add_u32 m0, s57, 4256
    s_nop 0
    buffer_load_dwordx4 v2, s[8:11], s55 offen offset:1024 nt lds
    ds_read_b128 a[192:195], v3 offset:0
    ds_read_b128 a[196:199], v3 offset:64
    ds_read_b128 a[200:203], v3 offset:128
    ds_read_b128 a[204:207], v3 offset:192
    ds_read_b128 a[208:211], v3 offset:256
    ds_read_b128 a[212:215], v3 offset:320
    ds_read_b128 a[216:219], v3 offset:384
    ds_read_b128 a[220:223], v3 offset:448
    s_waitcnt lgkmcnt(0)
    v_mfma_f32_16x16x32_bf16 v[80:83], a[0:3], v[32:35], 0
    v_mfma_f32_16x16x32_bf16 v[80:83], a[4:7], v[36:39], v[80:83]
    v_mfma_f32_16x16x32_bf16 v[80:83], a[8:11], v[40:43], v[80:83]
    v_mfma_f32_16x16x32_bf16 v[80:83], a[12:15], v[44:47], v[80:83]
    v_mfma_f32_16x16x32_bf16 v[80:83], a[16:19], v[48:51], v[80:83]
    v_mfma_f32_16x16x32_bf16 v[80:83], a[20:23], v[52:55], v[80:83]
    v_mfma_f32_16x16x32_bf16 v[80:83], a[24:27], v[56:59], v[80:83]
    v_mfma_f32_16x16x32_bf16 v[80:83], a[28:31], v[60:63], v[80:83]
    s_waitcnt vmcnt(8)
    s_add_u32 m0, s57, 4288
    s_nop 0
    buffer_load_dwordx4 v2, s[8:11], s55 offen offset:2048 nt lds
    s_nop 3
    v_cndmask_b32 v64, v80, v81, s[98:99]
    v_cndmask_b32 v65, v82, v83, s[98:99]
    v_cvt_pk_bf16_f32 v64, 0, v64
    v_cvt_pk_bf16_f32 v65, 0, v65
    s_waitcnt lgkmcnt(0)
    s_waitcnt lgkmcnt(0)
    v_mfma_f32_16x16x32_bf16 v[84:87], a[32:35], v[32:35], 0
    v_mfma_f32_16x16x32_bf16 v[84:87], a[36:39], v[36:39], v[84:87]
    v_mfma_f32_16x16x32_bf16 v[84:87], a[40:43], v[40:43], v[84:87]
    v_mfma_f32_16x16x32_bf16 v[84:87], a[44:47], v[44:47], v[84:87]
    v_mfma_f32_16x16x32_bf16 v[84:87], a[48:51], v[48:51], v[84:87]
    v_mfma_f32_16x16x32_bf16 v[84:87], a[52:55], v[52:55], v[84:87]
    v_mfma_f32_16x16x32_bf16 v[84:87], a[56:59], v[56:59], v[84:87]
    v_mfma_f32_16x16x32_bf16 v[84:87], a[60:63], v[60:63], v[84:87]
    v_alignbit_b32 v26, v6, v6, 10
    s_add_u32 m0, s58, 5120
    s_mov_b32 s60, 5120
    v_bitop3_b32 v26, v1, v26, s37 bitop3:0x78
    buffer_load_dwordx4 v26, s[28:31], s60 offen  lds
    s_waitcnt vmcnt(8)
    s_add_u32 m0, s57, 4320
    s_nop 0
    buffer_load_dwordx4 v2, s[8:11], s55 offen offset:3072 nt lds
    v_cndmask_b32 v66, v84, v85, s[98:99]
    v_cndmask_b32 v67, v86, v87, s[98:99]
    v_cvt_pk_bf16_f32 v66, 0, v66
    v_cvt_pk_bf16_f32 v67, 0, v67
    s_waitcnt lgkmcnt(0)
    v_mfma_f32_16x16x32_bf16 v[88:91], a[64:67], v[32:35], 0
    v_mfma_f32_16x16x32_bf16 v[88:91], a[68:71], v[36:39], v[88:91]
    v_mfma_f32_16x16x32_bf16 v[88:91], a[72:75], v[40:43], v[88:91]
    v_mfma_f32_16x16x32_bf16 v[88:91], a[76:79], v[44:47], v[88:91]
    v_mfma_f32_16x16x32_bf16 v[88:91], a[80:83], v[48:51], v[88:91]
    v_mfma_f32_16x16x32_bf16 v[88:91], a[84:87], v[52:55], v[88:91]
    v_mfma_f32_16x16x32_bf16 v[88:91], a[88:91], v[56:59], v[88:91]
    v_mfma_f32_16x16x32_bf16 v[88:91], a[92:95], v[60:63], v[88:91]
    s_waitcnt vmcnt(8)
    v_lshrrev_b32 v5, 3, v0
    v_lshlrev_b32 v5, 9, v5
    v_and_b32 v26, 0x70, v1
    v_or_b32 v5, v5, v26
    s_lshl_b32 s59, s3, 3
    v_xor_b32 v26, s59, v0
    v_and_b32 v26, 8, v26
    v_lshl_add_u32 v5, v26, 13, v5
    s_add_u32 s59, s5, 1
    s_and_b32 s59, s59, 3
    s_lshl_b32 s59, s59, 7
    v_and_b32 v5, 0xfffffe7f, v5
    v_or_b32 v5, s59, v5
    buffer_load_dwordx4 a[0:3], v5, s[12:15], s40 offen nt
    v_cndmask_b32 v68, v88, v89, s[98:99]
    v_cndmask_b32 v69, v90, v91, s[98:99]
    v_cvt_pk_bf16_f32 v68, 0, v68
    v_cvt_pk_bf16_f32 v69, 0, v69
    s_waitcnt lgkmcnt(0)
    v_mfma_f32_16x16x32_bf16 v[92:95], a[96:99], v[32:35], 0
    v_mfma_f32_16x16x32_bf16 v[92:95], a[100:103], v[36:39], v[92:95]
    v_mfma_f32_16x16x32_bf16 v[92:95], a[104:107], v[40:43], v[92:95]
    v_mfma_f32_16x16x32_bf16 v[92:95], a[108:111], v[44:47], v[92:95]
    v_mfma_f32_16x16x32_bf16 v[92:95], a[112:115], v[48:51], v[92:95]
    v_mfma_f32_16x16x32_bf16 v[92:95], a[116:119], v[52:55], v[92:95]
    v_mfma_f32_16x16x32_bf16 v[92:95], a[120:123], v[56:59], v[92:95]
    v_mfma_f32_16x16x32_bf16 v[92:95], a[124:127], v[60:63], v[92:95]
    v_alignbit_b32 v26, v6, v6, 12
    s_add_u32 m0, s58, 6144
    s_mov_b32 s60, 6144
    v_bitop3_b32 v26, v1, v26, s37 bitop3:0x78
    buffer_load_dwordx4 v26, s[28:31], s60 offen  lds
    s_waitcnt vmcnt(8)
    buffer_load_dwordx4 a[4:7], v5, s[12:15], s41 offen nt
    s_nop 0
    v_cndmask_b32 v70, v92, v93, s[98:99]
    v_cndmask_b32 v71, v94, v95, s[98:99]
    v_cvt_pk_bf16_f32 v70, 0, v70
    v_cvt_pk_bf16_f32 v71, 0, v71
    s_waitcnt lgkmcnt(0)
    v_mfma_f32_16x16x32_bf16 v[80:83], a[128:131], v[32:35], 0
    v_mfma_f32_16x16x32_bf16 v[80:83], a[132:135], v[36:39], v[80:83]
    v_mfma_f32_16x16x32_bf16 v[80:83], a[136:139], v[40:43], v[80:83]
    v_mfma_f32_16x16x32_bf16 v[80:83], a[140:143], v[44:47], v[80:83]
    v_mfma_f32_16x16x32_bf16 v[80:83], a[144:147], v[48:51], v[80:83]
    v_mfma_f32_16x16x32_bf16 v[80:83], a[148:151], v[52:55], v[80:83]
    v_mfma_f32_16x16x32_bf16 v[80:83], a[152:155], v[56:59], v[80:83]
    v_mfma_f32_16x16x32_bf16 v[80:83], a[156:159], v[60:63], v[80:83]
    s_waitcnt vmcnt(8)
    buffer_load_dwordx4 a[8:11], v5, s[12:15], s42 offen nt
    s_nop 5
    v_cndmask_b32 v72, v80, v81, s[98:99]
    v_cndmask_b32 v73, v82, v83, s[98:99]
    v_cvt_pk_bf16_f32 v72, 0, v72
    v_cvt_pk_bf16_f32 v73, 0, v73
    s_waitcnt lgkmcnt(0)
    v_mfma_f32_16x16x32_bf16 v[84:87], a[160:163], v[32:35], 0
    v_mfma_f32_16x16x32_bf16 v[84:87], a[164:167], v[36:39], v[84:87]
    v_mfma_f32_16x16x32_bf16 v[84:87], a[168:171], v[40:43], v[84:87]
    v_mfma_f32_16x16x32_bf16 v[84:87], a[172:175], v[44:47], v[84:87]
    v_mfma_f32_16x16x32_bf16 v[84:87], a[176:179], v[48:51], v[84:87]
    v_mfma_f32_16x16x32_bf16 v[84:87], a[180:183], v[52:55], v[84:87]
    v_mfma_f32_16x16x32_bf16 v[84:87], a[184:187], v[56:59], v[84:87]
    v_mfma_f32_16x16x32_bf16 v[84:87], a[188:191], v[60:63], v[84:87]
    v_and_b32 v2, 24, v0
    v_lshlrev_b32 v2, 2, v2
    s_waitcnt vmcnt(7)
    buffer_load_dwordx4 a[12:15], v5, s[12:15], s43 offen nt
    s_nop 3
    v_cndmask_b32 v74, v84, v85, s[98:99]
    v_cndmask_b32 v75, v86, v87, s[98:99]
    v_cvt_pk_bf16_f32 v74, 0, v74
    v_cvt_pk_bf16_f32 v75, 0, v75
    s_waitcnt lgkmcnt(0)
    v_mfma_f32_16x16x32_bf16 v[88:91], a[192:195], v[32:35], 0
    v_mfma_f32_16x16x32_bf16 v[88:91], a[196:199], v[36:39], v[88:91]
    v_mfma_f32_16x16x32_bf16 v[88:91], a[200:203], v[40:43], v[88:91]
    v_mfma_f32_16x16x32_bf16 v[88:91], a[204:207], v[44:47], v[88:91]
    v_mfma_f32_16x16x32_bf16 v[88:91], a[208:211], v[48:51], v[88:91]
    v_mfma_f32_16x16x32_bf16 v[88:91], a[212:215], v[52:55], v[88:91]
    v_mfma_f32_16x16x32_bf16 v[88:91], a[216:219], v[56:59], v[88:91]
    v_mfma_f32_16x16x32_bf16 v[88:91], a[220:223], v[60:63], v[88:91]
    v_alignbit_b32 v26, v6, v6, 14
    s_add_u32 m0, s58, 7168
    s_mov_b32 s60, 7168
    v_bitop3_b32 v26, v1, v26, s37 bitop3:0x78
    buffer_load_dwordx4 v26, s[28:31], s60 offen  lds
    s_waitcnt vmcnt(8)
    buffer_load_dwordx4 a[16:19], v5, s[12:15], s44 offen nt
    s_nop 0
    v_cndmask_b32 v76, v88, v89, s[98:99]
    v_cndmask_b32 v77, v90, v91, s[98:99]
    v_cvt_pk_bf16_f32 v76, 0, v76
    v_cvt_pk_bf16_f32 v77, 0, v77
    s_waitcnt vmcnt(7)
    buffer_load_dwordx4 a[20:23], v5, s[12:15], s45 offen nt
    v_alignbit_b32 v26, v6, v6, 16
    s_add_u32 m0, s58, 8192
    s_mov_b32 s60, 8192
    v_bitop3_b32 v26, v1, v26, s37 bitop3:0x78
    buffer_load_dwordx4 v26, s[28:31], s60 offen  lds
    s_waitcnt vmcnt(8)
    buffer_load_dwordx4 a[24:27], v5, s[12:15], s46 offen nt
    ds_read_b128 a[224:227], v4 offset:0
    ds_read_b128 a[228:231], v4 offset:64
    ds_read_b128 a[232:235], v4 offset:128
    ds_read_b128 a[236:239], v4 offset:192
    ds_read_b128 a[240:243], v4 offset:256
    ds_read_b128 a[244:247], v4 offset:320
    ds_read_b128 a[248:251], v4 offset:384
    ds_read_b128 a[252:255], v4 offset:448
    s_waitcnt vmcnt(7)
    buffer_load_dwordx4 a[28:31], v5, s[12:15], s47 offen nt
    s_waitcnt lgkmcnt(0)
    s_waitcnt lgkmcnt(0)
    v_mfma_f32_16x16x32_bf16 v[92:95], a[224:227], v[32:35], 0
    v_mfma_f32_16x16x32_bf16 v[92:95], a[228:231], v[36:39], v[92:95]
    v_mfma_f32_16x16x32_bf16 v[92:95], a[232:235], v[40:43], v[92:95]
    v_mfma_f32_16x16x32_bf16 v[92:95], a[236:239], v[44:47], v[92:95]
    v_mfma_f32_16x16x32_bf16 v[92:95], a[240:243], v[48:51], v[92:95]
    v_mfma_f32_16x16x32_bf16 v[92:95], a[244:247], v[52:55], v[92:95]
    v_mfma_f32_16x16x32_bf16 v[92:95], a[248:251], v[56:59], v[92:95]
    v_mfma_f32_16x16x32_bf16 v[92:95], a[252:255], v[60:63], v[92:95]
    v_alignbit_b32 v26, v6, v6, 18
    s_add_u32 m0, s58, 9216
    s_mov_b32 s60, 9216
    v_bitop3_b32 v26, v1, v26, s37 bitop3:0x78
    buffer_load_dwordx4 v26, s[28:31], s60 offen  lds
    s_waitcnt vmcnt(8)
    buffer_load_dwordx4 a[32:35], v5, s[12:15], s48 offen nt
    s_nop 0
    v_cndmask_b32 v78, v92, v93, s[98:99]
    v_cndmask_b32 v79, v94, v95, s[98:99]
    v_cvt_pk_bf16_f32 v78, 0, v78
    v_cvt_pk_bf16_f32 v79, 0, v79
    v_max3_f32 v28, v64, v65, v66
    v_max3_f32 v28, v28, v67, v68
    v_max3_f32 v28, v28, v69, v70
    v_max3_f32 v28, v28, v71, v72
    v_max3_f32 v28, v28, v73, v74
    v_max3_f32 v28, v28, v75, v76
    v_max3_f32 v28, v28, v77, v78
    v_max_f32 v28, v28, v79
    s_nop 1
    v_max_f32_dpp v28, v28, v28 row_ror:8 row_mask:0xf bank_mask:0xf
    v_mov_b32 v24, v28
    s_nop 1
    v_permlane16_swap_b32 v28, v24
    v_max_f32 v28, v28, v24
    v_mov_b32 v24, v28
    s_nop 1
    v_permlane32_swap_b32 v28, v24
    v_max_f32 v28, v28, v24
    s_waitcnt vmcnt(8)
    buffer_load_dwordx4 a[36:39], v5, s[12:15], s49 offen nt
    s_mov_b32 s59, 1035512379
    v_sub_f32 v64, v64, v28
    v_sub_f32 v65, v65, v28
    v_sub_f32 v66, v66, v28
    v_sub_f32 v67, v67, v28
    v_sub_f32 v68, v68, v28
    v_sub_f32 v69, v69, v28
    v_sub_f32 v70, v70, v28
    v_sub_f32 v71, v71, v28
    v_sub_f32 v72, v72, v28
    v_sub_f32 v73, v73, v28
    v_sub_f32 v74, v74, v28
    v_sub_f32 v75, v75, v28
    v_sub_f32 v76, v76, v28
    v_sub_f32 v77, v77, v28
    v_sub_f32 v78, v78, v28
    v_sub_f32 v79, v79, v28
    v_mul_f32 v64, s59, v64
    v_mul_f32 v65, s59, v65
    v_mul_f32 v66, s59, v66
    v_mul_f32 v67, s59, v67
    v_mul_f32 v68, s59, v68
    v_mul_f32 v69, s59, v69
    v_mul_f32 v70, s59, v70
    v_mul_f32 v71, s59, v71
    v_mul_f32 v72, s59, v72
    v_mul_f32 v73, s59, v73
    v_mul_f32 v74, s59, v74
    v_mul_f32 v75, s59, v75
    v_mul_f32 v76, s59, v76
    v_mul_f32 v77, s59, v77
    v_mul_f32 v78, s59, v78
    v_mul_f32 v79, s59, v79
    v_alignbit_b32 v26, v6, v6, 20
    s_add_u32 m0, s58, 10240
    s_mov_b32 s60, 10240
    v_bitop3_b32 v26, v1, v26, s37 bitop3:0x78
    buffer_load_dwordx4 v26, s[28:31], s60 offen  lds
    s_waitcnt vmcnt(8)
    buffer_load_dwordx4 a[40:43], v5, s[12:15], s50 offen nt
    v_exp_f32 v64, v64
    v_exp_f32 v65, v65
    v_exp_f32 v66, v66
    v_exp_f32 v67, v67
    v_exp_f32 v68, v68
    v_exp_f32 v69, v69
    v_exp_f32 v70, v70
    v_exp_f32 v71, v71
    v_exp_f32 v72, v72
    v_exp_f32 v73, v73
    v_exp_f32 v74, v74
    v_exp_f32 v75, v75
    v_exp_f32 v76, v76
    v_exp_f32 v77, v77
    v_exp_f32 v78, v78
    v_exp_f32 v79, v79
    v_add_f32 v29, v64, v65
    v_add_f32 v29, v29, v66
    v_add_f32 v29, v29, v67
    v_add_f32 v29, v29, v68
    v_add_f32 v29, v29, v69
    v_add_f32 v29, v29, v70
    v_add_f32 v29, v29, v71
    v_add_f32 v29, v29, v72
    v_add_f32 v29, v29, v73
    v_add_f32 v29, v29, v74
    v_add_f32 v29, v29, v75
    v_add_f32 v29, v29, v76
    v_add_f32 v29, v29, v77
    v_add_f32 v29, v29, v78
    v_add_f32 v29, v29, v79
    v_and_b32 v24, 48, v0
    v_add_u32 v24, v24, v0
    s_lshl2_add_u32 s59, s6, s3
    s_mul_i32 s59, s59, 112
    v_add_lshl_u32 v25, v24, s59, 1
    v_cmp_lt_u32 s[100:101], 15, v0
    v_add_u32 v24, -32, v25
    s_nop 0
    v_cndmask_b32 v24, v25, v24, s[100:101]
    s_mul_i32 s59, s6, 5376
    s_add_u32 s59, s59, 983040
    v_lshl_add_u32 v3, v24, 1, s59
    v_lshl_add_u32 v4, v25, 1, s59
    global_load_short_d16_hi v18, v24, s[64:65]
    global_load_short_d16_hi v19, v25, s[64:65]
    buffer_load_dword v22, v3, s[16:19], 0 offen offset:1792 sc1
    buffer_load_dword v23, v4, s[16:19], 0 offen offset:1792 sc1
    buffer_load_dword v20, v3, s[16:19], 0 offen offset:3584 sc1
    buffer_load_dword v21, v4, s[16:19], 0 offen offset:3584 sc1
    s_waitcnt vmcnt(14)
    buffer_load_dwordx4 a[44:47], v5, s[12:15], s51 offen nt
    v_add_f32_dpp v29, v29, v29 row_ror:8 row_mask:0xf bank_mask:0xf
    v_mov_b32 v24, v29
    s_nop 1
    v_permlane16_swap_b32 v29, v24
    v_add_f32 v29, v29, v24
    v_mov_b32 v24, v29
    s_nop 1
    v_permlane32_swap_b32 v29, v24
    v_add_f32 v29, v29, v24
    s_lshl3_add_u32 s59, s6, s4
    s_lshl_b32 s59, s59, 9
    s_add_u32 s59, s59, 917504
    v_and_b32 v30, 31, v0
    v_lshl_add_u32 v30, v30, 4, s59
    s_lshl2_add_u32 s60, s5, s3
    s_lshl4_add_u32 s59, s60, s59
    v_lshl_add_u32 v24, v0, 6, s59
    v_and_b32 v25, 59, v0
    v_cmp_eq_u32 vcc, 0, v25
    v_mov_b32 v25, 1073741824
    s_nop 0
    v_cndmask_b32 v24, v25, v24, vcc
    v_or_b32 v92, s89, v28
    v_mov_b32 v93, v29
    v_mov_b32 v94, s88
    buffer_store_dwordx3 v[92:94], v24, s[16:19], 0 offen
    v_alignbit_b32 v26, v6, v6, 22
    s_add_u32 m0, s58, 11264
    s_mov_b32 s60, 11264
    v_bitop3_b32 v26, v1, v26, s37 bitop3:0x78
    buffer_load_dwordx4 v26, s[28:31], s60 offen  lds
    s_waitcnt vmcnt(15)
    buffer_load_dwordx4 a[48:51], v5, s[12:15], s52 offen nt
    v_cvt_pk_bf16_f32 v64, v64, v64
    v_cvt_pk_bf16_f32 v65, v65, v65
    v_cvt_pk_bf16_f32 v66, v66, v66
    v_cvt_pk_bf16_f32 v67, v67, v67
    v_cvt_pk_bf16_f32 v68, v68, v68
    v_cvt_pk_bf16_f32 v69, v69, v69
    v_cvt_pk_bf16_f32 v70, v70, v70
    v_cvt_pk_bf16_f32 v71, v71, v71
    v_and_b32 v32, v64, v10
    v_and_b32 v33, v64, v11
    v_and_b32 v34, v65, v10
    v_and_b32 v35, v65, v11
    v_and_b32 v36, v66, v10
    v_and_b32 v37, v66, v11
    v_and_b32 v38, v67, v10
    v_and_b32 v39, v67, v11
    v_and_b32 v40, v68, v10
    v_and_b32 v41, v68, v11
    v_and_b32 v42, v69, v10
    v_and_b32 v43, v69, v11
    v_and_b32 v44, v70, v10
    v_and_b32 v45, v70, v11
    v_and_b32 v46, v71, v10
    v_and_b32 v47, v71, v11
    s_waitcnt vmcnt(15)
    buffer_load_dwordx4 a[52:55], v5, s[12:15], s53 offen nt
    v_cvt_pk_bf16_f32 v72, v72, v72
    v_cvt_pk_bf16_f32 v73, v73, v73
    v_cvt_pk_bf16_f32 v74, v74, v74
    v_cvt_pk_bf16_f32 v75, v75, v75
    v_cvt_pk_bf16_f32 v76, v76, v76
    v_cvt_pk_bf16_f32 v77, v77, v77
    v_cvt_pk_bf16_f32 v78, v78, v78
    v_cvt_pk_bf16_f32 v79, v79, v79
    v_and_b32 v48, v72, v10
    v_and_b32 v49, v72, v11
    v_and_b32 v50, v73, v10
    v_and_b32 v51, v73, v11
    v_and_b32 v52, v74, v10
    v_and_b32 v53, v74, v11
    v_and_b32 v54, v75, v10
    v_and_b32 v55, v75, v11
    v_and_b32 v56, v76, v10
    v_and_b32 v57, v76, v11
    v_and_b32 v58, v77, v10
    v_and_b32 v59, v77, v11
    v_and_b32 v60, v78, v10
    v_and_b32 v61, v78, v11
    v_and_b32 v62, v79, v10
    v_and_b32 v63, v79, v11
    v_alignbit_b32 v26, v6, v6, 24
    s_add_u32 m0, s58, 12288
    s_mov_b32 s60, 12288
    v_bitop3_b32 v26, v1, v26, s37 bitop3:0x78
    buffer_load_dwordx4 v26, s[28:31], s60 offen  lds
    s_waitcnt vmcnt(15)
    buffer_load_dwordx4 a[56:59], v5, s[12:15], s54 offen nt
    v_mfma_f32_16x16x16_bf16 v[96:99], v[32:33], a[0:1], 0
    v_mfma_f32_16x16x16_bf16 v[100:103], v[32:33], a[2:3], 0
    v_mfma_f32_16x16x16_bf16 v[96:99], v[34:35], a[4:5], v[96:99]
    v_mfma_f32_16x16x16_bf16 v[100:103], v[34:35], a[6:7], v[100:103]
    v_mfma_f32_16x16x16_bf16 v[96:99], v[36:37], a[8:9], v[96:99]
    v_mfma_f32_16x16x16_bf16 v[100:103], v[36:37], a[10:11], v[100:103]
    s_waitcnt vmcnt(15)
    buffer_load_dwordx4 a[60:63], v5, s[12:15], s55 offen nt
    v_mfma_f32_16x16x16_bf16 v[96:99], v[38:39], a[12:13], v[96:99]
    v_mfma_f32_16x16x16_bf16 v[100:103], v[38:39], a[14:15], v[100:103]
    v_mfma_f32_16x16x16_bf16 v[96:99], v[40:41], a[16:17], v[96:99]
    v_mfma_f32_16x16x16_bf16 v[100:103], v[40:41], a[18:19], v[100:103]
    v_mfma_f32_16x16x16_bf16 v[96:99], v[42:43], a[20:21], v[96:99]
    v_mfma_f32_16x16x16_bf16 v[100:103], v[42:43], a[22:23], v[100:103]
    v_alignbit_b32 v26, v6, v6, 26
    s_add_u32 m0, s58, 13312
    s_mov_b32 s60, 13312
    v_bitop3_b32 v26, v1, v26, s37 bitop3:0x78
    buffer_load_dwordx4 v26, s[28:31], s60 offen  lds
    s_add_u32 s59, s5, 2
    s_and_b32 s59, s59, 3
    s_lshl_b32 s59, s59, 7
    v_and_b32 v5, 0xfffffe7f, v5
    v_or_b32 v5, s59, v5
    buffer_load_dwordx4 a[64:67], v5, s[12:15], s40 offen nt
    v_mfma_f32_16x16x16_bf16 v[96:99], v[44:45], a[24:25], v[96:99]
    v_mfma_f32_16x16x16_bf16 v[100:103], v[44:45], a[26:27], v[100:103]
    v_mfma_f32_16x16x16_bf16 v[96:99], v[46:47], a[28:29], v[96:99]
    v_mfma_f32_16x16x16_bf16 v[100:103], v[46:47], a[30:31], v[100:103]
    v_mfma_f32_16x16x16_bf16 v[96:99], v[48:49], a[32:33], v[96:99]
    v_mfma_f32_16x16x16_bf16 v[100:103], v[48:49], a[34:35], v[100:103]
    s_waitcnt vmcnt(16)
    buffer_load_dwordx4 a[68:71], v5, s[12:15], s41 offen nt
    v_mfma_f32_16x16x16_bf16 v[96:99], v[50:51], a[36:37], v[96:99]
    v_mfma_f32_16x16x16_bf16 v[100:103], v[50:51], a[38:39], v[100:103]
    v_mfma_f32_16x16x16_bf16 v[96:99], v[52:53], a[40:41], v[96:99]
    v_mfma_f32_16x16x16_bf16 v[100:103], v[52:53], a[42:43], v[100:103]
    s_waitcnt vmcnt(10)
    buffer_load_dwordx4 a[72:75], v5, s[12:15], s42 offen nt
    v_mfma_f32_16x16x16_bf16 v[96:99], v[54:55], a[44:45], v[96:99]
    v_mfma_f32_16x16x16_bf16 v[100:103], v[54:55], a[46:47], v[100:103]
    v_alignbit_b32 v26, v6, v6, 0
    s_add_u32 m0, s57, 0
    s_mov_b32 s60, 229376
    v_bitop3_b32 v26, v1, v26, s37 bitop3:0x78
    buffer_load_dwordx4 v26, s[28:31], s60 offen  lds
    s_waitcnt vmcnt(9)
    buffer_load_dwordx4 a[76:79], v5, s[12:15], s43 offen nt
    v_mfma_f32_16x16x16_bf16 v[96:99], v[56:57], a[48:49], v[96:99]
    v_mfma_f32_16x16x16_bf16 v[100:103], v[56:57], a[50:51], v[100:103]
    s_waitcnt vmcnt(9)
    buffer_load_dwordx4 a[80:83], v5, s[12:15], s44 offen nt
    v_mfma_f32_16x16x16_bf16 v[96:99], v[58:59], a[52:53], v[96:99]
    v_mfma_f32_16x16x16_bf16 v[100:103], v[58:59], a[54:55], v[100:103]
    v_alignbit_b32 v26, v6, v6, 2
    s_add_u32 m0, s57, 1024
    s_mov_b32 s60, 230400
    v_bitop3_b32 v26, v1, v26, s37 bitop3:0x78
    buffer_load_dwordx4 v26, s[28:31], s60 offen  lds
    s_waitcnt vmcnt(9)
    buffer_load_dwordx4 a[84:87], v5, s[12:15], s45 offen nt
    v_mfma_f32_16x16x16_bf16 v[96:99], v[60:61], a[56:57], v[96:99]
    v_mfma_f32_16x16x16_bf16 v[100:103], v[60:61], a[58:59], v[100:103]
    v_and_b32 v24, 1, v0
    v_mul_u32_u24 v10, 0xaaaa, v24
    v_bfe_u32 v25, v0, 2, 1
    v_mul_u32_u24 v25, 0xaaaa, v25
    v_lshl_or_b32 v10, v25, 16, v10
    v_add_u32 v10, 0x44444444, v10
    v_lshlrev_b32 v24, 4, v24
    v_bfe_u32 v29, s88, v24, 16
    v_and_b32 v11, 0xbfff, v29
    v_mov_b32 v25, 0x3f80
    v_lshlrev_b32 v25, v24, v25
    v_and_b32 v24, 13, v0
    v_cmp_eq_u32 vcc, 0, v24
    s_nop 1
    v_cndmask_b32 v25, v25, 0, vcc
    v_cndmask_b32 v124, 0, v25, s[94:95]
    v_cndmask_b32 v125, 0, v25, s[98:99]
    v_cndmask_b32 v126, 0, v25, s[94:95]
    v_cndmask_b32 v127, 0, v25, s[98:99]
    s_waitcnt vmcnt(9)
    buffer_load_dwordx4 a[88:91], v5, s[12:15], s46 offen nt
    v_mfma_f32_16x16x16_bf16 v[96:99], v[62:63], a[60:61], v[96:99]
    v_mfma_f32_16x16x16_bf16 v[100:103], v[62:63], a[62:63], v[100:103]
    v_alignbit_b32 v26, v6, v6, 4
    s_add_u32 m0, s57, 2048
    s_mov_b32 s60, 231424
    v_bitop3_b32 v26, v1, v26, s37 bitop3:0x78
    buffer_load_dwordx4 v26, s[28:31], s60 offen  lds
L_mod_chk_10:
    v_xor_b32 v22, v29, v22
    v_xor_b32 v23, v29, v23
    v_xor_b32 v20, v29, v20
    v_xor_b32 v21, v29, v21
    v_or_b32 v24, v22, v23
    v_or3_b32 v24, v24, v20, v21
    v_cmp_ne_u16 vcc, 0, v24
    s_cbranch_vccz L_mod_ok_11
    buffer_load_dword v22, v3, s[16:19], 0 offen offset:1792 sc1
    buffer_load_dword v23, v4, s[16:19], 0 offen offset:1792 sc1
    buffer_load_dword v20, v3, s[16:19], 0 offen offset:3584 sc1
    buffer_load_dword v21, v4, s[16:19], 0 offen offset:3584 sc1
    s_add_u32 s92, s92, 1
    s_cmp_gt_u32 s92, 1048576
    s_cbranch_scc1 L_mod_giveup_12
    s_and_b32 s63, s92, 63
    s_cbranch_scc1 L_nowb_13
    s_waitcnt vmcnt(0)
    buffer_wbl2 sc1
L_nowb_13:
    s_waitcnt vmcnt(0)
    s_branch L_mod_chk_10
L_mod_giveup_12:
    s_waitcnt vmcnt(0)
L_mod_ok_11:
    v_and_b32 v18, 0xffff0000, v18
    v_and_b32 v19, 0xffff0000, v19
    v_add_f32 v20, 1.0, v20
    v_cvt_pk_bf16_f32 v20, 0, v20
    v_add_f32 v21, 1.0, v21
    v_cvt_pk_bf16_f32 v21, 0, v21
    v_cndmask_b32 v18, 0, v18, s[100:101]
    v_cndmask_b32 v20, 0, v20, s[100:101]
    v_cndmask_b32 v22, 0, v22, s[100:101]
    v_cvt_pk_bf16_f32 v24, v20, v21
    v_cvt_pk_bf16_f32 v25, v22, v23
    v_mov_b64 v[64:65], 0
    v_mov_b64 v[68:69], 0
    v_mov_b64 v[72:73], 0
    v_mov_b64 v[76:77], 0
    v_mov_b64 v[80:81], 0
    v_mov_b64 v[84:85], 0
    v_mov_b64 v[88:89], 0
    v_mov_b64 v[92:93], 0
    v_mov_b32_dpp v112, v24 quad_perm:[0,1,2,3] row_mask:0xf bank_mask:0xf
    s_nop 1
    v_mov_b32_dpp v112, v25 row_ror:4 row_mask:0xf bank_mask:0x2
    v_mov_b32_dpp v113, v24 row_ror:14 row_mask:0xf bank_mask:0xf
    s_nop 1
    v_mov_b32_dpp v113, v25 row_ror:2 row_mask:0xf bank_mask:0x2
    v_mov_b32_dpp v114, v24 row_ror:12 row_mask:0xf bank_mask:0xf
    s_nop 1
    v_mov_b32_dpp v114, v25 quad_perm:[0,1,2,3] row_mask:0xf bank_mask:0x2
    v_mov_b32_dpp v115, v24 row_ror:10 row_mask:0xf bank_mask:0xf
    s_nop 1
    v_mov_b32_dpp v115, v25 row_ror:14 row_mask:0xf bank_mask:0x2
    v_mov_b32_dpp v116, v24 row_ror:8 row_mask:0xf bank_mask:0xf
    s_nop 1
    v_mov_b32_dpp v116, v25 row_ror:12 row_mask:0xf bank_mask:0x2
    v_mov_b32_dpp v117, v24 row_ror:6 row_mask:0xf bank_mask:0xf
    s_nop 1
    v_mov_b32_dpp v117, v25 row_ror:10 row_mask:0xf bank_mask:0x2
    v_mov_b32_dpp v118, v24 row_ror:4 row_mask:0xf bank_mask:0xf
    s_nop 1
    v_mov_b32_dpp v118, v25 row_ror:8 row_mask:0xf bank_mask:0x2
    v_mov_b32_dpp v119, v24 row_ror:2 row_mask:0xf bank_mask:0xf
    s_nop 1
    v_mov_b32_dpp v119, v25 row_ror:6 row_mask:0xf bank_mask:0x2
    s_waitcnt vmcnt(9)
    buffer_load_dwordx4 a[92:95], v5, s[12:15], s47 offen nt
    v_mfma_f32_16x16x16_bf16 v[104:107], v[32:33], a[64:65], 0
    v_mfma_f32_16x16x16_bf16 v[108:111], v[32:33], a[66:67], 0
    v_smfmac_f32_16x16x64_bf16 v[64:67], v[112:115], v[128:135], v10
    v_smfmac_f32_16x16x64_bf16 v[68:71], v[112:115], v[144:151], v10
    v_smfmac_f32_16x16x64_bf16 v[72:75], v[112:115], v[160:167], v10
    v_smfmac_f32_16x16x64_bf16 v[76:79], v[112:115], v[176:183], v10
    v_smfmac_f32_16x16x64_bf16 v[80:83], v[112:115], v[192:199], v10
    v_smfmac_f32_16x16x64_bf16 v[84:87], v[112:115], v[208:215], v10
    v_smfmac_f32_16x16x64_bf16 v[88:91], v[112:115], v[224:231], v10
    v_smfmac_f32_16x16x64_bf16 v[92:95], v[112:115], v[240:247], v10
    v_smfmac_f32_16x16x64_bf16 v[64:67], v[116:119], v[136:143], v10
    v_smfmac_f32_16x16x64_bf16 v[68:71], v[116:119], v[152:159], v10
    v_smfmac_f32_16x16x64_bf16 v[72:75], v[116:119], v[168:175], v10
    v_smfmac_f32_16x16x64_bf16 v[76:79], v[116:119], v[184:191], v10
    v_smfmac_f32_16x16x64_bf16 v[80:83], v[116:119], v[200:207], v10
    v_smfmac_f32_16x16x64_bf16 v[84:87], v[116:119], v[216:223], v10
    v_smfmac_f32_16x16x64_bf16 v[88:91], v[116:119], v[232:239], v10
    v_smfmac_f32_16x16x64_bf16 v[92:95], v[116:119], v[248:255], v10
    s_waitcnt vmcnt(9)
    buffer_load_dwordx4 a[96:99], v5, s[12:15], s48 offen nt
    v_mfma_f32_16x16x16_bf16 v[104:107], v[34:35], a[68:69], v[104:107]
    v_mfma_f32_16x16x16_bf16 v[108:111], v[34:35], a[70:71], v[108:111]
    v_alignbit_b32 v26, v6, v6, 6
    s_add_u32 m0, s57, 3072
    s_mov_b32 s60, 232448
    v_bitop3_b32 v26, v1, v26, s37 bitop3:0x78
    buffer_load_dwordx4 v26, s[28:31], s60 offen  lds
    v_add_f32 v112, v64, v65
    v_add_f32 v114, v68, v69
    v_add_f32 v116, v72, v73
    v_add_f32 v118, v76, v77
    v_add_f32 v113, v80, v81
    v_add_f32 v115, v84, v85
    v_add_f32 v117, v88, v89
    v_add_f32 v119, v92, v93
    s_lshl_b32 s59, s3, 9
    s_add_u32 s59, s59, 160000
    v_and_b32 v24, 15, v0
    v_lshl_add_u32 v22, v24, 5, s59
    s_nop 0
    v_mov_b32_dpp v25, v24 quad_perm:[0,2,1,3] row_mask:0xf bank_mask:0xf
    v_lshrrev_b32 v24, 4, v0
    v_lshlrev_b32 v24, 3, v24
    v_lshl_add_u32 v24, v25, 5, v24
    v_add_u32 v23, 160000, v24
    v_add_u32 v24, -2304, v22
    v_cndmask_b32 v24, v24, v22, s[100:101]
    s_mov_b32 exec_hi, 0
    ds_write_b128 v24, v[112:115]
    ds_write_b128 v24, v[116:119] offset:16
    s_mov_b64 exec, -1
    s_waitcnt vmcnt(10)
    buffer_load_dwordx4 a[100:103], v5, s[12:15], s49 offen nt
    v_mfma_f32_16x16x16_bf16 v[104:107], v[36:37], a[72:73], v[104:107]
    v_mfma_f32_16x16x16_bf16 v[108:111], v[36:37], a[74:75], v[108:111]
    s_waitcnt lgkmcnt(0)
    s_barrier
    v_add_u32 v24, -2304, v23
    ds_read2st64_b64 v[64:67], v24 offset0:0 offset1:1
    ds_read2st64_b64 v[68:71], v24 offset0:2 offset1:3
    ds_read2st64_b64 v[72:75], v23 offset0:0 offset1:1
    ds_read2st64_b64 v[76:79], v23 offset0:2 offset1:3
    s_waitcnt lgkmcnt(0)
    v_pk_add_f32 v[64:65], v[64:65], v[66:67]
    v_pk_add_f32 v[68:69], v[68:69], v[70:71]
    v_pk_add_f32 v[120:121], v[64:65], v[68:69]
    v_pk_add_f32 v[72:73], v[72:73], v[74:75]
    v_pk_add_f32 v[76:77], v[76:77], v[78:79]
    v_pk_add_f32 v[122:123], v[72:73], v[76:77]
    s_lshl_b32 s59, s5, 8
    v_add_u32 v24, s59, v1
    s_movk_i32 s59, 0x3ff
    v_bfi_b32 v14, s59, v24, v13
    s_waitcnt vmcnt(9)
    buffer_load_dwordx4 a[104:107], v5, s[12:15], s50 offen nt
    v_mfma_f32_16x16x16_bf16 v[104:107], v[38:39], a[76:77], v[104:107]
    v_mfma_f32_16x16x16_bf16 v[108:111], v[38:39], a[78:79], v[108:111]
    v_alignbit_b32 v26, v6, v6, 8
    s_add_u32 m0, s57, 4096
    s_mov_b32 s60, 233472
    v_bitop3_b32 v26, v1, v26, s37 bitop3:0x78
    buffer_load_dwordx4 v26, s[28:31], s60 offen  lds
    s_add_u32 s59, s36, 57344
    v_xad_u32 v27, v2, s59, v9
    ds_read_b64_tr_b16 a[128:129], v27 offset:0
    ds_read_b64_tr_b16 a[130:131], v27 offset:3584
    ds_read_b64_tr_b16 a[132:133], v27 offset:28672
    ds_read_b64_tr_b16 a[134:135], v27 offset:32256
    s_add_u32 s59, s36, 57376
    v_xad_u32 v27, v2, s59, v9
    ds_read_b64_tr_b16 a[144:145], v27 offset:0
    ds_read_b64_tr_b16 a[146:147], v27 offset:3584
    ds_read_b64_tr_b16 a[148:149], v27 offset:28672
    ds_read_b64_tr_b16 a[150:151], v27 offset:32256
    s_add_u32 s59, s36, 57408
    v_xad_u32 v27, v2, s59, v9
    ds_read_b64_tr_b16 a[160:161], v27 offset:0
    ds_read_b64_tr_b16 a[162:163], v27 offset:3584
    ds_read_b64_tr_b16 a[164:165], v27 offset:28672
    ds_read_b64_tr_b16 a[166:167], v27 offset:32256
    s_add_u32 s59, s36, 57440
    v_xad_u32 v27, v2, s59, v9
    ds_read_b64_tr_b16 a[176:177], v27 offset:0
    ds_read_b64_tr_b16 a[178:179], v27 offset:3584
    ds_read_b64_tr_b16 a[180:181], v27 offset:28672
    ds_read_b64_tr_b16 a[182:183], v27 offset:32256
    s_waitcnt vmcnt(10)
    buffer_load_dwordx4 a[108:111], v5, s[12:15], s51 offen nt
    v_mfma_f32_16x16x16_bf16 v[104:107], v[40:41], a[80:81], v[104:107]
    v_mfma_f32_16x16x16_bf16 v[108:111], v[40:41], a[82:83], v[108:111]
    s_add_u32 s59, s36, 57472
    v_xad_u32 v27, v2, s59, v9
    ds_read_b64_tr_b16 a[192:193], v27 offset:0
    ds_read_b64_tr_b16 a[194:195], v27 offset:3584
    ds_read_b64_tr_b16 a[196:197], v27 offset:28672
    ds_read_b64_tr_b16 a[198:199], v27 offset:32256
    s_add_u32 s59, s36, 57504
    v_xad_u32 v27, v2, s59, v9
    ds_read_b64_tr_b16 a[208:209], v27 offset:0
    ds_read_b64_tr_b16 a[210:211], v27 offset:3584
    ds_read_b64_tr_b16 a[212:213], v27 offset:28672
    ds_read_b64_tr_b16 a[214:215], v27 offset:32256
    s_add_u32 s59, s36, 57536
    v_xad_u32 v27, v2, s59, v9
    ds_read_b64_tr_b16 a[224:225], v27 offset:0
    ds_read_b64_tr_b16 a[226:227], v27 offset:3584
    ds_read_b64_tr_b16 a[228:229], v27 offset:28672
    ds_read_b64_tr_b16 a[230:231], v27 offset:32256
    buffer_load_dwordx3 v[80:82], v30, s[16:19], 0 offen sc1
    s_waitcnt vmcnt(10)
    buffer_load_dwordx4 a[112:115], v5, s[12:15], s52 offen nt
    v_mfma_f32_16x16x16_bf16 v[104:107], v[42:43], a[84:85], v[104:107]
    v_mfma_f32_16x16x16_bf16 v[108:111], v[42:43], a[86:87], v[108:111]
    v_alignbit_b32 v26, v6, v6, 10
    s_add_u32 m0, s57, 5120
    s_mov_b32 s60, 234496
    v_bitop3_b32 v26, v1, v26, s37 bitop3:0x78
    buffer_load_dwordx4 v26, s[28:31], s60 offen  lds
    s_waitcnt vmcnt(11)
    buffer_load_dwordx4 a[116:119], v5, s[12:15], s53 offen nt
    v_mfma_f32_16x16x16_bf16 v[104:107], v[44:45], a[88:89], v[104:107]
    v_mfma_f32_16x16x16_bf16 v[108:111], v[44:45], a[90:91], v[108:111]
    s_waitcnt vmcnt(10)
    buffer_load_dwordx4 a[120:123], v5, s[12:15], s54 offen nt
    v_mfma_f32_16x16x16_bf16 v[104:107], v[46:47], a[92:93], v[104:107]
    v_mfma_f32_16x16x16_bf16 v[108:111], v[46:47], a[94:95], v[108:111]
    v_alignbit_b32 v26, v6, v6, 12
    s_add_u32 m0, s57, 6144
    s_mov_b32 s60, 235520
    v_bitop3_b32 v26, v1, v26, s37 bitop3:0x78
    buffer_load_dwordx4 v26, s[28:31], s60 offen  lds
    s_waitcnt vmcnt(11)
    buffer_load_dwordx4 a[124:127], v5, s[12:15], s55 offen nt
    v_mfma_f32_16x16x16_bf16 v[104:107], v[48:49], a[96:97], v[104:107]
    v_mfma_f32_16x16x16_bf16 v[108:111], v[48:49], a[98:99], v[108:111]
    s_waitcnt vmcnt(10)
    s_add_u32 s59, s5, 3
    s_and_b32 s59, s59, 3
    s_lshl_b32 s59, s59, 7
    v_and_b32 v5, 0xfffffe7f, v5
    v_or_b32 v5, s59, v5
    buffer_load_dwordx4 a[0:3], v5, s[12:15], s40 offen nt
    v_mfma_f32_16x16x16_bf16 v[104:107], v[50:51], a[100:101], v[104:107]
    v_mfma_f32_16x16x16_bf16 v[108:111], v[50:51], a[102:103], v[108:111]
    s_waitcnt vmcnt(10)
    buffer_load_dwordx4 a[4:7], v5, s[12:15], s41 offen nt
    v_mfma_f32_16x16x16_bf16 v[104:107], v[52:53], a[104:105], v[104:107]
    v_mfma_f32_16x16x16_bf16 v[108:111], v[52:53], a[106:107], v[108:111]
    v_alignbit_b32 v26, v6, v6, 14
    s_add_u32 m0, s57, 7168
    s_mov_b32 s60, 236544
    v_bitop3_b32 v26, v1, v26, s37 bitop3:0x78
    buffer_load_dwordx4 v26, s[28:31], s60 offen  lds
    s_waitcnt vmcnt(10)
    buffer_load_dwordx4 a[8:11], v5, s[12:15], s42 offen nt
    v_mfma_f32_16x16x16_bf16 v[104:107], v[54:55], a[108:109], v[104:107]
    v_mfma_f32_16x16x16_bf16 v[108:111], v[54:55], a[110:111], v[108:111]
    s_waitcnt vmcnt(9)
    buffer_load_dwordx4 a[12:15], v5, s[12:15], s43 offen nt
    v_mfma_f32_16x16x16_bf16 v[104:107], v[56:57], a[112:113], v[104:107]
    v_mfma_f32_16x16x16_bf16 v[108:111], v[56:57], a[114:115], v[108:111]
    v_alignbit_b32 v26, v6, v6, 16
    s_add_u32 m0, s57, 8192
    s_mov_b32 s60, 237568
    v_bitop3_b32 v26, v1, v26, s37 bitop3:0x78
    buffer_load_dwordx4 v26, s[28:31], s60 offen  lds
L_ml_chk_14:
    v_xor_b32 v80, s89, v80
    v_xor_b32 v82, s88, v82
    v_lshl_or_b32 v82, v80, 16, v82
    v_cmp_ne_u32 vcc, 0, v82
    s_cbranch_vccz L_ml_ok_15
    buffer_load_dwordx3 v[80:82], v30, s[16:19], 0 offen sc1
    s_add_u32 s92, s92, 1
    s_cmp_gt_u32 s92, 1048576
    s_cbranch_scc1 L_ml_giveup_16
    s_and_b32 s63, s92, 63
    s_cbranch_scc1 L_nowb_17
    s_waitcnt vmcnt(0)
    buffer_wbl2 sc1
L_nowb_17:
    s_waitcnt vmcnt(0)
    s_branch L_ml_chk_14
L_ml_giveup_16:
    s_waitcnt vmcnt(0)
L_ml_ok_15:
    v_max_f32_dpp v82, v80, v80 row_ror:8 row_mask:0xf bank_mask:0xf
    s_nop 1
    v_max_f32_dpp v82, v82, v82 row_ror:4 row_mask:0xf bank_mask:0xf
    s_nop 1
    v_max_f32_dpp v82, v82, v82 row_ror:2 row_mask:0xf bank_mask:0xf
    s_nop 1
    v_max_f32_dpp v82, v82, v82 row_ror:1 row_mask:0xf bank_mask:0xf
    s_mov_b32 s59, 1035512379
    v_sub_f32 v83, v80, v82
    v_mul_f32 v83, s59, v83
    v_exp_f32 v83, v83
    s_nop 0
    v_mul_f32 v83, v83, v81
    s_nop 1
    v_add_f32_dpp v83, v83, v83 row_ror:8 row_mask:0xf bank_mask:0xf
    s_nop 1
    v_add_f32_dpp v83, v83, v83 row_ror:4 row_mask:0xf bank_mask:0xf
    s_nop 1
    v_add_f32_dpp v83, v83, v83 row_ror:2 row_mask:0xf bank_mask:0xf
    s_nop 1
    v_add_f32_dpp v83, v83, v83 row_ror:1 row_mask:0xf bank_mask:0xf
    v_mov_b32_dpp v80, v28 row_newbcast:0 row_mask:0x5 bank_mask:0xf
    s_nop 1
    v_mov_b32_dpp v80, v28 row_newbcast:4 row_mask:0xa bank_mask:0xf
    v_sub_f32 v82, v80, v82
    v_mul_f32 v82, s59, v82
    v_exp_f32 v82, v82
    v_rcp_f32 v83, v83
    s_nop 0
    v_mul_f32 v28, v82, v83
    s_waitcnt vmcnt(9)
    buffer_load_dwordx4 a[16:19], v5, s[12:15], s44 offen nt
    v_permlane32_swap_b32 v96, v100
    v_permlane32_swap_b32 v97, v101
    v_permlane32_swap_b32 v98, v102
    v_permlane32_swap_b32 v99, v103
    v_add_f32_dpp v96, v100, v96 row_ror:8 row_mask:0xf bank_mask:0xf
    v_add_f32_dpp v97, v101, v97 row_ror:8 row_mask:0xf bank_mask:0xf
    v_add_f32_dpp v98, v102, v98 row_ror:8 row_mask:0xf bank_mask:0xf
    v_add_f32_dpp v99, v103, v99 row_ror:8 row_mask:0xf bank_mask:0xf
    v_mul_f32 v96, v96, v28
    v_mul_f32 v97, v97, v28
    v_mul_f32 v98, v98, v28
    v_mul_f32 v99, v99, v28
    s_lshl_b32 s59, s3, 9
    s_add_u32 s59, s59, 151552
    v_add_u32 v31, s59, v12
    s_mov_b64 exec, s[94:95]
    ds_write_b128 v31, v[96:99] offset:0
    s_mov_b64 exec, -1
    v_mfma_f32_16x16x16_bf16 v[104:107], v[58:59], a[116:117], v[104:107]
    v_mfma_f32_16x16x16_bf16 v[108:111], v[58:59], a[118:119], v[108:111]
    s_waitcnt vmcnt(9)
    buffer_load_dwordx4 a[20:23], v5, s[12:15], s45 offen nt
    v_mfma_f32_16x16x16_bf16 v[104:107], v[60:61], a[120:121], v[104:107]
    v_mfma_f32_16x16x16_bf16 v[108:111], v[60:61], a[122:123], v[108:111]
    v_alignbit_b32 v26, v6, v6, 18
    s_add_u32 m0, s57, 9216
    s_mov_b32 s60, 238592
    v_bitop3_b32 v26, v1, v26, s37 bitop3:0x78
    buffer_load_dwordx4 v26, s[28:31], s60 offen  lds
    s_waitcnt vmcnt(9)
    buffer_load_dwordx4 a[24:27], v5, s[12:15], s46 offen nt
    v_mfma_f32_16x16x16_bf16 v[104:107], v[62:63], a[124:125], v[104:107]
    v_mfma_f32_16x16x16_bf16 v[108:111], v[62:63], a[126:127], v[108:111]
    s_waitcnt vmcnt(9)
    buffer_load_dwordx4 a[28:31], v5, s[12:15], s47 offen nt
    s_nop 5
    v_permlane32_swap_b32 v104, v108
    v_permlane32_swap_b32 v105, v109
    v_permlane32_swap_b32 v106, v110
    v_permlane32_swap_b32 v107, v111
    v_add_f32_dpp v104, v108, v104 row_ror:8 row_mask:0xf bank_mask:0xf
    v_add_f32_dpp v105, v109, v105 row_ror:8 row_mask:0xf bank_mask:0xf
    v_add_f32_dpp v106, v110, v106 row_ror:8 row_mask:0xf bank_mask:0xf
    v_add_f32_dpp v107, v111, v107 row_ror:8 row_mask:0xf bank_mask:0xf
    v_mul_f32 v104, v104, v28
    v_mul_f32 v105, v105, v28
    v_mul_f32 v106, v106, v28
    v_mul_f32 v107, v107, v28
    s_mov_b64 exec, s[94:95]
    ds_write_b128 v31, v[104:107] offset:2048
    s_mov_b64 exec, -1
    v_mfma_f32_16x16x16_bf16 v[96:99], v[32:33], a[0:1], 0
    v_mfma_f32_16x16x16_bf16 v[100:103], v[32:33], a[2:3], 0
    v_alignbit_b32 v26, v6, v6, 20
    s_add_u32 m0, s57, 10240
    s_mov_b32 s60, 239616
    v_bitop3_b32 v26, v1, v26, s37 bitop3:0x78
    buffer_load_dwordx4 v26, s[28:31], s60 offen  lds
    s_waitcnt vmcnt(10)
    buffer_load_dwordx4 a[32:35], v5, s[12:15], s48 offen nt
    v_mfma_f32_16x16x16_bf16 v[96:99], v[34:35], a[4:5], v[96:99]
    v_mfma_f32_16x16x16_bf16 v[100:103], v[34:35], a[6:7], v[100:103]
    s_lshl4_add_u32 s59, s3, s4
    s_lshl_b32 s59, s59, 9
    s_add_u32 s59, s59, 917504
    v_bfe_u32 v68, v0, 4, 1
    v_lshlrev_b32 v68, 12, v68
    v_and_b32 v69, 15, v0
    v_lshlrev_b32 v69, 4, v69
    v_add3_u32 v68, v68, v69, s59
    buffer_load_dwordx3 v[64:66], v68, s[16:19], 0 offen sc1
    s_waitcnt vmcnt(10)
    buffer_load_dwordx4 a[36:39], v5, s[12:15], s49 offen nt
    v_mfma_f32_16x16x16_bf16 v[96:99], v[36:37], a[8:9], v[96:99]
    v_mfma_f32_16x16x16_bf16 v[100:103], v[36:37], a[10:11], v[100:103]
    v_alignbit_b32 v26, v6, v6, 22
    s_add_u32 m0, s57, 11264
    s_mov_b32 s60, 240640
    v_bitop3_b32 v26, v1, v26, s37 bitop3:0x78
    buffer_load_dwordx4 v26, s[28:31], s60 offen  lds
    s_waitcnt vmcnt(11)
    buffer_load_dwordx4 a[40:43], v5, s[12:15], s50 offen nt
    v_mfma_f32_16x16x16_bf16 v[96:99], v[38:39], a[12:13], v[96:99]
    v_mfma_f32_16x16x16_bf16 v[100:103], v[38:39], a[14:15], v[100:103]
    s_waitcnt vmcnt(10)
    buffer_load_dwordx4 a[44:47], v5, s[12:15], s51 offen nt
    v_mfma_f32_16x16x16_bf16 v[96:99], v[40:41], a[16:17], v[96:99]
    v_mfma_f32_16x16x16_bf16 v[100:103], v[40:41], a[18:19], v[100:103]
    v_alignbit_b32 v26, v6, v6, 24
    s_add_u32 m0, s57, 12288
    s_mov_b32 s60, 241664
    v_bitop3_b32 v26, v1, v26, s37 bitop3:0x78
    buffer_load_dwordx4 v26, s[28:31], s60 offen  lds
    s_waitcnt vmcnt(11)
    buffer_load_dwordx4 a[48:51], v5, s[12:15], s52 offen nt
    v_mfma_f32_16x16x16_bf16 v[96:99], v[42:43], a[20:21], v[96:99]
    v_mfma_f32_16x16x16_bf16 v[100:103], v[42:43], a[22:23], v[100:103]
    s_waitcnt vmcnt(10)
    buffer_load_dwordx4 a[52:55], v5, s[12:15], s53 offen nt
    v_mfma_f32_16x16x16_bf16 v[96:99], v[44:45], a[24:25], v[96:99]
    v_mfma_f32_16x16x16_bf16 v[100:103], v[44:45], a[26:27], v[100:103]
    v_alignbit_b32 v26, v6, v6, 26
    s_add_u32 m0, s57, 13312
    s_mov_b32 s60, 242688
    v_bitop3_b32 v26, v1, v26, s37 bitop3:0x78
    buffer_load_dwordx4 v26, s[28:31], s60 offen  lds
    s_waitcnt vmcnt(11)
    buffer_load_dwordx4 a[56:59], v5, s[12:15], s54 offen nt
    v_mfma_f32_16x16x16_bf16 v[96:99], v[46:47], a[28:29], v[96:99]
    v_mfma_f32_16x16x16_bf16 v[100:103], v[46:47], a[30:31], v[100:103]
    s_waitcnt vmcnt(10)
    buffer_load_dwordx4 a[60:63], v5, s[12:15], s55 offen nt
    v_mfma_f32_16x16x16_bf16 v[96:99], v[48:49], a[32:33], v[96:99]
    v_mfma_f32_16x16x16_bf16 v[100:103], v[48:49], a[34:35], v[100:103]
    s_waitcnt vmcnt(9)
    s_add_u32 s59, s5, 4
    s_and_b32 s59, s59, 3
    s_lshl_b32 s59, s59, 7
    v_and_b32 v5, 0xfffffe7f, v5
    v_or_b32 v5, s59, v5
    buffer_load_dwordx4 a[64:67], v5, s[12:15], s40 offen nt
    v_mfma_f32_16x16x16_bf16 v[96:99], v[50:51], a[36:37], v[96:99]
    v_mfma_f32_16x16x16_bf16 v[100:103], v[50:51], a[38:39], v[100:103]
L_grp_chk_18:
    v_xor_b32 v64, s89, v64
    v_xor_b32 v66, s88, v66
    v_lshl_or_b32 v66, v64, 16, v66
    v_cmp_ne_u32 vcc, 0, v66
    s_cbranch_vccz L_grp_ok_19
    buffer_load_dwordx3 v[64:66], v68, s[16:19], 0 offen sc1
    s_add_u32 s92, s92, 1
    s_cmp_gt_u32 s92, 1048576
    s_cbranch_scc1 L_grp_giveup_20
    s_and_b32 s63, s92, 63
    s_cbranch_scc1 L_nowb_21
    s_waitcnt vmcnt(0)
    buffer_wbl2 sc1
L_nowb_21:
    s_waitcnt vmcnt(0)
    s_branch L_grp_chk_18
L_grp_giveup_20:
    s_waitcnt vmcnt(0)
L_grp_ok_19:
    s_waitcnt vmcnt(8)
    buffer_load_dwordx4 a[68:71], v5, s[12:15], s41 offen nt
    v_mfma_f32_16x16x16_bf16 v[96:99], v[52:53], a[40:41], v[96:99]
    v_mfma_f32_16x16x16_bf16 v[100:103], v[52:53], a[42:43], v[100:103]
    s_waitcnt vmcnt(8)
    buffer_load_dwordx4 a[72:75], v5, s[12:15], s42 offen nt
    v_mfma_f32_16x16x16_bf16 v[96:99], v[54:55], a[44:45], v[96:99]
    v_mfma_f32_16x16x16_bf16 v[100:103], v[54:55], a[46:47], v[100:103]
    s_getpc_b64 s[38:39]
L_pc_22:
    s_sub_u32 s38, s38, L_pc_22-adaLN_cond__sliding_block_cached__glu_gated_swiglu__decode_kernel
    s_subb_u32 s39, s39, 0
    s_mul_i32 s59, s6, 3
    s_add_u32 s59, s59, s5
    s_lshl2_add_u32 s59, s59, s3
    s_mul_i32 s59, s59, 384
    v_min_u32 v24, 2, v0
    v_lshl_add_u32 v24, v24, 7, s59
    v_min_u32 v24, L_codeend-adaLN_cond__sliding_block_cached__glu_gated_swiglu__decode_kernel-4, v24
    v_mov_b32 v25, s39
    v_add_co_u32 v24, vcc, s38, v24
    s_nop 1
    v_addc_co_u32 v25, vcc, 0, v25, vcc
    global_load_dword v119, v[24:25], off
    s_waitcnt vmcnt(8)
    buffer_load_dwordx4 a[76:79], v5, s[12:15], s43 offen nt
    v_mfma_f32_16x16x16_bf16 v[96:99], v[56:57], a[48:49], v[96:99]
    v_mfma_f32_16x16x16_bf16 v[100:103], v[56:57], a[50:51], v[100:103]
    s_waitcnt vmcnt(8)
    buffer_load_dwordx4 a[80:83], v5, s[12:15], s44 offen nt
    v_mfma_f32_16x16x16_bf16 v[96:99], v[58:59], a[52:53], v[96:99]
    v_mfma_f32_16x16x16_bf16 v[100:103], v[58:59], a[54:55], v[100:103]
    s_waitcnt vmcnt(7)
    buffer_load_dwordx4 a[84:87], v5, s[12:15], s45 offen nt
    v_mfma_f32_16x16x16_bf16 v[96:99], v[60:61], a[56:57], v[96:99]
    v_mfma_f32_16x16x16_bf16 v[100:103], v[60:61], a[58:59], v[100:103]
    s_waitcnt vmcnt(7)
    buffer_load_dwordx4 a[88:91], v5, s[12:15], s46 offen nt
    v_mfma_f32_16x16x16_bf16 v[96:99], v[62:63], a[60:61], v[96:99]
    v_mfma_f32_16x16x16_bf16 v[100:103], v[62:63], a[62:63], v[100:103]
    s_waitcnt vmcnt(7)
    buffer_load_dwordx4 a[92:95], v5, s[12:15], s47 offen nt
    s_nop 5
    v_permlane32_swap_b32 v96, v100
    v_permlane32_swap_b32 v97, v101
    v_permlane32_swap_b32 v98, v102
    v_permlane32_swap_b32 v99, v103
    v_add_f32_dpp v96, v100, v96 row_ror:8 row_mask:0xf bank_mask:0xf
    v_add_f32_dpp v97, v101, v97 row_ror:8 row_mask:0xf bank_mask:0xf
    v_add_f32_dpp v98, v102, v98 row_ror:8 row_mask:0xf bank_mask:0xf
    v_add_f32_dpp v99, v103, v99 row_ror:8 row_mask:0xf bank_mask:0xf
    v_mul_f32 v96, v96, v28
    v_mul_f32 v97, v97, v28
    v_mul_f32 v98, v98, v28
    v_mul_f32 v99, v99, v28
    s_mov_b64 exec, s[94:95]
    ds_write_b128 v31, v[96:99] offset:4096
    s_mov_b64 exec, -1
    v_mfma_f32_16x16x16_bf16 v[104:107], v[32:33], a[64:65], 0
    v_mfma_f32_16x16x16_bf16 v[108:111], v[32:33], a[66:67], 0
    s_waitcnt lgkmcnt(0)
    s_barrier
    s_lshl_b32 s59, s3, 11
    s_add_u32 s59, s59, 151552
    v_add_u32 v24, s59, v12
    ds_read_b128 v[80:83], v24 offset:0
    ds_read_b128 v[84:87], v24 offset:512
    ds_read_b128 v[88:91], v24 offset:1024
    ds_read_b128 v[92:95], v24 offset:1536
    s_mul_i32 s59, s7, 57344
    s_add_u32 s59, s59, s57
    s_add_u32 s32, s80, s59
    s_addc_u32 s33, s81, 0
    s_mov_b32 s34, 14336
    s_mov_b32 s35, 0x20000
    s_waitcnt vmcnt(7)
    buffer_load_dwordx4 a[96:99], v5, s[12:15], s48 offen nt
    v_mfma_f32_16x16x16_bf16 v[104:107], v[34:35], a[68:69], v[104:107]
    v_mfma_f32_16x16x16_bf16 v[108:111], v[34:35], a[70:71], v[108:111]
    s_add_u32 s59, s5, s3
    s_add_u32 s59, s59, 1
    s_and_b32 s59, s59, 3
    s_lshl_b32 s59, s59, 3
    s_and_b32 s60, s2, 0xe7
    s_or_b32 s59, s59, s60
    s_mul_i32 s59, s59, 1536
    s_lshl_b32 s60, s3, 9
    s_add_u32 s60, s60, 524288
    s_cmp_eq_u32 s3, 3
    s_cselect_b32 s60, 1073741824, s60
    s_add_u32 s59, s59, s60
    s_mul_i32 s61, s2, 1536
    s_add_u32 s60, s60, s61
    v_and_b32 v30, 48, v0
    v_and_b32 v26, 7, v0
    v_lshlrev_b32 v26, 4, v26
    v_lshl_add_u32 v30, v30, 3, v26
    v_add_u32 v25, s59, v30
    v_mov_b32 v26, 1073741824
    v_cndmask_b32 v25, v26, v25, s[94:95]
    v_add_u32 v30, s60, v30
    v_and_b32 v26, 3, v0
    v_lshlrev_b32 v26, 3, v26
    v_lshrrev_b32 v103, v26, s88
    v_bfe_u32 v100, v103, 0, 2
    v_bfe_u32 v101, v103, 2, 2
    v_bfe_u32 v102, v103, 4, 2
    v_bfe_u32 v103, v103, 6, 2
    s_waitcnt lgkmcnt(0)
    v_add_f32 v80, v80, v84
    v_add_f32 v88, v88, v92
    v_add_f32 v81, v81, v85
    v_add_f32 v89, v89, v93
    v_add_f32 v82, v82, v86
    v_add_f32 v90, v90, v94
    v_add_f32 v83, v83, v87
    v_add_f32 v91, v91, v95
    v_add_f32 v84, v80, v88
    v_add_f32 v85, v81, v89
    v_add_f32 v86, v82, v90
    v_add_f32 v87, v83, v91
    v_bfi_b32 v84, 3, v100, v84
    v_bfi_b32 v85, 3, v101, v85
    v_bfi_b32 v86, 3, v102, v86
    v_bfi_b32 v87, 3, v103, v87
    buffer_store_dwordx4 v[84:87], v25, s[16:19], 0 offen
    s_cmp_eq_u32 s3, 3
    s_cselect_b32 s59, 0, 3
    v_and_b32 v100, s59, v100
    v_and_b32 v101, s59, v101
    v_and_b32 v102, s59, v102
    v_and_b32 v103, s59, v103
    s_waitcnt vmcnt(8)
    buffer_load_dwordx4 a[100:103], v5, s[12:15], s49 offen nt
    v_mfma_f32_16x16x16_bf16 v[104:107], v[36:37], a[72:73], v[104:107]
    v_mfma_f32_16x16x16_bf16 v[108:111], v[36:37], a[74:75], v[108:111]
    s_add_u32 s59, s36, 0
    v_xad_u32 v27, v2, s59, v9
    ds_read_b64_tr_b16 a[136:137], v27 offset:0
    ds_read_b64_tr_b16 a[138:139], v27 offset:3584
    ds_read_b64_tr_b16 a[140:141], v27 offset:28672
    ds_read_b64_tr_b16 a[142:143], v27 offset:32256
    s_add_u32 s59, s36, 32
    v_xad_u32 v27, v2, s59, v9
    ds_read_b64_tr_b16 a[152:153], v27 offset:0
    ds_read_b64_tr_b16 a[154:155], v27 offset:3584
    ds_read_b64_tr_b16 a[156:157], v27 offset:28672
    ds_read_b64_tr_b16 a[158:159], v27 offset:32256
    s_add_u32 s59, s36, 64
    v_xad_u32 v27, v2, s59, v9
    ds_read_b64_tr_b16 a[168:169], v27 offset:0
    ds_read_b64_tr_b16 a[170:171], v27 offset:3584
    ds_read_b64_tr_b16 a[172:173], v27 offset:28672
    ds_read_b64_tr_b16 a[174:175], v27 offset:32256
    s_add_u32 s59, s36, 96
    v_xad_u32 v27, v2, s59, v9
    ds_read_b64_tr_b16 a[184:185], v27 offset:0
    ds_read_b64_tr_b16 a[186:187], v27 offset:3584
    ds_read_b64_tr_b16 a[188:189], v27 offset:28672
    ds_read_b64_tr_b16 a[190:191], v27 offset:32256
    buffer_load_dwordx4 a[104:107], v5, s[12:15], s50 offen nt
    s_add_u32 s59, s36, 128
    v_xad_u32 v27, v2, s59, v9
    ds_read_b64_tr_b16 a[200:201], v27 offset:0
    ds_read_b64_tr_b16 a[202:203], v27 offset:3584
    ds_read_b64_tr_b16 a[204:205], v27 offset:28672
    ds_read_b64_tr_b16 a[206:207], v27 offset:32256
    s_add_u32 s59, s36, 160
    v_xad_u32 v27, v2, s59, v9
    ds_read_b64_tr_b16 a[216:217], v27 offset:0
    ds_read_b64_tr_b16 a[218:219], v27 offset:3584
    ds_read_b64_tr_b16 a[220:221], v27 offset:28672
    ds_read_b64_tr_b16 a[222:223], v27 offset:32256
    s_add_u32 s59, s36, 192
    v_xad_u32 v27, v2, s59, v9
    ds_read_b64_tr_b16 a[232:233], v27 offset:0
    ds_read_b64_tr_b16 a[234:235], v27 offset:3584
    ds_read_b64_tr_b16 a[236:237], v27 offset:28672
    ds_read_b64_tr_b16 a[238:239], v27 offset:32256
    s_waitcnt vmcnt(8)
    buffer_load_dwordx4 a[108:111], v5, s[12:15], s51 offen nt
    v_mfma_f32_16x16x16_bf16 v[104:107], v[38:39], a[76:77], v[104:107]
    v_mfma_f32_16x16x16_bf16 v[108:111], v[38:39], a[78:79], v[108:111]
    buffer_load_dwordx4 v[96:99], v30, s[16:19], 0 offen sc1
    s_waitcnt vmcnt(9)
    buffer_load_dwordx4 a[112:115], v5, s[12:15], s52 offen nt
    v_mfma_f32_16x16x16_bf16 v[104:107], v[40:41], a[80:81], v[104:107]
    v_mfma_f32_16x16x16_bf16 v[108:111], v[40:41], a[82:83], v[108:111]
    s_waitcnt vmcnt(9)
    buffer_load_dwordx4 a[116:119], v5, s[12:15], s53 offen nt
    v_mfma_f32_16x16x16_bf16 v[104:107], v[42:43], a[84:85], v[104:107]
    v_mfma_f32_16x16x16_bf16 v[108:111], v[42:43], a[86:87], v[108:111]
    s_waitcnt vmcnt(9)
    buffer_load_dwordx4 a[120:123], v5, s[12:15], s54 offen nt
    v_mfma_f32_16x16x16_bf16 v[104:107], v[44:45], a[88:89], v[104:107]
    v_mfma_f32_16x16x16_bf16 v[108:111], v[44:45], a[90:91], v[108:111]
    s_waitcnt vmcnt(9)
    buffer_load_dwordx4 a[124:127], v5, s[12:15], s55 offen nt
    v_mfma_f32_16x16x16_bf16 v[104:107], v[46:47], a[92:93], v[104:107]
    v_mfma_f32_16x16x16_bf16 v[108:111], v[46:47], a[94:95], v[108:111]
    s_lshl2_add_u32 s59, s4, s5
    s_lshl_b32 s59, s59, 8
    s_add_u32 s48, s59, 1048576
    s_lshl_b32 s59, s7, 8
    s_add_u32 s49, s59, 1310720
    s_lshl_b32 s59, s3, 9
    s_add_u32 s59, s59, 157696
    v_add_u32 v31, s59, v12
    s_add_u32 s59, s4, 1
    s_and_b32 s59, s59, 7
    s_lshl_b32 s59, s59, 10
    s_add_u32 s40, s59, 1048576
    s_add_u32 s59, s4, 2
    s_and_b32 s59, s59, 7
    s_lshl_b32 s59, s59, 10
    s_add_u32 s41, s59, 1048576
    s_add_u32 s59, s4, 3
    s_and_b32 s59, s59, 7
    s_lshl_b32 s59, s59, 10
    s_add_u32 s42, s59, 1048576
    s_add_u32 s59, s4, 4
    s_and_b32 s59, s59, 7
    s_lshl_b32 s59, s59, 10
    s_add_u32 s43, s59, 1048576
    s_add_u32 s59, s4, 5
    s_and_b32 s59, s59, 7
    s_lshl_b32 s59, s59, 10
    s_add_u32 s44, s59, 1048576
    s_add_u32 s59, s4, 6
    s_and_b32 s59, s59, 7
    s_lshl_b32 s59, s59, 10
    s_add_u32 s45, s59, 1048576
    s_add_u32 s59, s4, 7
    s_and_b32 s59, s59, 7
    s_lshl_b32 s59, s59, 10
    s_add_u32 s46, s59, 1048576
    s_add_u32 s59, s4, 8
    s_and_b32 s59, s59, 7
    s_lshl_b32 s59, s59, 10
    s_add_u32 s47, s59, 1048576
    s_waitcnt vmcnt(9)
    v_mfma_f32_16x16x16_bf16 v[104:107], v[48:49], a[96:97], v[104:107]
    v_mfma_f32_16x16x16_bf16 v[108:111], v[48:49], a[98:99], v[108:111]
    s_waitcnt vmcnt(7)
    v_mfma_f32_16x16x16_bf16 v[104:107], v[50:51], a[100:101], v[104:107]
    v_mfma_f32_16x16x16_bf16 v[108:111], v[50:51], a[102:103], v[108:111]
    s_waitcnt vmcnt(6)
    v_mfma_f32_16x16x16_bf16 v[104:107], v[52:53], a[104:105], v[104:107]
    v_mfma_f32_16x16x16_bf16 v[108:111], v[52:53], a[106:107], v[108:111]
    s_waitcnt vmcnt(5)
    v_mfma_f32_16x16x16_bf16 v[104:107], v[54:55], a[108:109], v[104:107]
    v_mfma_f32_16x16x16_bf16 v[108:111], v[54:55], a[110:111], v[108:111]
    s_waitcnt vmcnt(4)
L_of_chk_23:
    v_xor_b32 v96, v100, v96
    v_xor_b32 v97, v101, v97
    v_xor_b32 v98, v102, v98
    v_xor_b32 v99, v103, v99
    v_or3_b32 v24, v96, v97, v98
    v_or_b32 v24, v24, v99
    v_and_b32 v24, 3, v24
    v_cmp_ne_u32 vcc, 0, v24
    s_cbranch_vccz L_of_ok_24
    buffer_load_dwordx4 v[96:99], v30, s[16:19], 0 offen sc1
    s_add_u32 s92, s92, 1
    s_cmp_gt_u32 s92, 1048576
    s_cbranch_scc1 L_of_giveup_25
    s_and_b32 s63, s92, 63
    s_cbranch_scc1 L_nowb_26
    s_waitcnt vmcnt(0)
    buffer_wbl2 sc1
L_nowb_26:
    s_waitcnt vmcnt(0)
    s_branch L_of_chk_23
L_of_giveup_25:
    s_waitcnt vmcnt(0)
L_of_ok_24:
    s_waitcnt vmcnt(3)
    v_mfma_f32_16x16x16_bf16 v[104:107], v[56:57], a[112:113], v[104:107]
    v_mfma_f32_16x16x16_bf16 v[108:111], v[56:57], a[114:115], v[108:111]
    s_waitcnt vmcnt(2)
    v_mfma_f32_16x16x16_bf16 v[104:107], v[58:59], a[116:117], v[104:107]
    v_mfma_f32_16x16x16_bf16 v[108:111], v[58:59], a[118:119], v[108:111]
    s_waitcnt vmcnt(1)
    v_mfma_f32_16x16x16_bf16 v[104:107], v[60:61], a[120:121], v[104:107]
    v_mfma_f32_16x16x16_bf16 v[108:111], v[60:61], a[122:123], v[108:111]
    s_waitcnt vmcnt(0)
    v_mfma_f32_16x16x16_bf16 v[104:107], v[62:63], a[124:125], v[104:107]
    v_mfma_f32_16x16x16_bf16 v[108:111], v[62:63], a[126:127], v[108:111]
    s_nop 7
    v_permlane32_swap_b32 v104, v108
    v_permlane32_swap_b32 v105, v109
    v_permlane32_swap_b32 v106, v110
    v_permlane32_swap_b32 v107, v111
    v_add_f32_dpp v104, v108, v104 row_ror:8 row_mask:0xf bank_mask:0xf
    v_add_f32_dpp v105, v109, v105 row_ror:8 row_mask:0xf bank_mask:0xf
    v_add_f32_dpp v106, v110, v106 row_ror:8 row_mask:0xf bank_mask:0xf
    v_add_f32_dpp v107, v111, v107 row_ror:8 row_mask:0xf bank_mask:0xf
    v_fma_f32 v104, v104, v28, v96
    v_fma_f32 v105, v105, v28, v97
    v_fma_f32 v106, v106, v28, v98
    v_fma_f32 v107, v107, v28, v99
    s_mov_b64 exec, s[94:95]
    ds_write_b128 v31, v[104:107]
    s_mov_b64 exec, -1
    v_alignbit_b32 v26, v6, v6, 0
    s_add_u32 m0, s58, 0
    s_mov_b32 s60, 0
    v_bitop3_b32 v26, v1, v26, s37 bitop3:0x78
    buffer_load_dwordx4 v26, s[32:35], s60 offen  lds
    v_alignbit_b32 v26, v6, v6, 2
    s_add_u32 m0, s58, 1024
    s_mov_b32 s60, 1024
    v_bitop3_b32 v26, v1, v26, s37 bitop3:0x78
    buffer_load_dwordx4 v26, s[32:35], s60 offen  lds
    v_mov_b64 v[32:33], 0
    v_mov_b64 v[36:37], 0
    v_mov_b64 v[40:41], 0
    v_mov_b64 v[44:45], 0
    v_mov_b64 v[48:49], 0
    v_mov_b64 v[52:53], 0
    v_mov_b64 v[56:57], 0
    s_waitcnt lgkmcnt(0)
    s_barrier
    ds_read2st64_b64 v[96:99], v15 offset0:0 offset1:1
    ds_read2st64_b64 v[100:103], v15 offset0:2 offset1:3
    v_alignbit_b32 v26, v6, v6, 4
    s_add_u32 m0, s58, 2048
    s_mov_b32 s60, 2048
    v_bitop3_b32 v26, v1, v26, s37 bitop3:0x78
    buffer_load_dwordx4 v26, s[32:35], s60 offen  lds
    v_alignbit_b32 v26, v6, v6, 6
    s_add_u32 m0, s58, 3072
    s_mov_b32 s60, 3072
    v_bitop3_b32 v26, v1, v26, s37 bitop3:0x78
    buffer_load_dwordx4 v26, s[32:35], s60 offen  lds
    v_alignbit_b32 v26, v6, v6, 8
    s_add_u32 m0, s58, 4096
    s_mov_b32 s60, 4096
    v_bitop3_b32 v26, v1, v26, s37 bitop3:0x78
    buffer_load_dwordx4 v26, s[32:35], s60 offen  lds
    s_waitcnt lgkmcnt(1)
    v_pk_add_f32 v[96:97], v[96:97], v[98:99]
    s_waitcnt lgkmcnt(0)
    v_pk_add_f32 v[100:101], v[100:101], v[102:103]
    v_pk_add_f32 v[96:97], v[96:97], v[100:101]
    v_cvt_pk_bf16_f32 v112, v96, v97
    s_nop 1
    v_mov_b32_dpp v113, v112 row_ror:14 row_mask:0xf bank_mask:0xf
    v_mov_b32_dpp v114, v112 row_ror:12 row_mask:0xf bank_mask:0xf
    v_mov_b32_dpp v115, v112 row_ror:10 row_mask:0xf bank_mask:0xf
    s_nop 1
    v_smfmac_f32_16x16x64_bf16 v[32:35], v[112:115], a[128:135], v10
    v_mov_b32_dpp v116, v112 row_ror:8 row_mask:0xf bank_mask:0xf
    v_smfmac_f32_16x16x64_bf16 v[36:39], v[112:115], a[144:151], v10
    v_mov_b32_dpp v117, v112 row_ror:6 row_mask:0xf bank_mask:0xf
    v_smfmac_f32_16x16x64_bf16 v[40:43], v[112:115], a[160:167], v10
    v_mov_b32_dpp v118, v112 row_ror:4 row_mask:0xf bank_mask:0xf
    v_smfmac_f32_16x16x64_bf16 v[44:47], v[112:115], a[176:183], v10
    v_mov_b32_dpp v119, v112 row_ror:2 row_mask:0xf bank_mask:0xf
    v_smfmac_f32_16x16x64_bf16 v[48:51], v[112:115], a[192:199], v10
    v_smfmac_f32_16x16x64_bf16 v[52:55], v[112:115], a[208:215], v10
    v_smfmac_f32_16x16x64_bf16 v[56:59], v[112:115], a[224:231], v10
    v_smfmac_f32_16x16x64_bf16 v[32:35], v[116:119], a[136:143], v10
    v_smfmac_f32_16x16x64_bf16 v[36:39], v[116:119], a[152:159], v10
    v_smfmac_f32_16x16x64_bf16 v[40:43], v[116:119], a[168:175], v10
    v_smfmac_f32_16x16x64_bf16 v[44:47], v[116:119], a[184:191], v10
    v_smfmac_f32_16x16x64_bf16 v[48:51], v[116:119], a[200:207], v10
    v_smfmac_f32_16x16x64_bf16 v[52:55], v[116:119], a[216:223], v10
    v_smfmac_f32_16x16x64_bf16 v[56:59], v[116:119], a[232:239], v10
    s_mov_b64 exec, 0xffff
    s_nop 0
    v_add_f32 v32, v32, v33
    v_add_f32 v36, v36, v37
    v_add_f32 v40, v40, v41
    v_cvt_pk_bf16_f32 v92, 0, v32
    v_add_f32 v44, v44, v45
    v_cvt_pk_bf16_f32 v93, v36, v40
    v_add_f32 v48, v48, v49
    v_or_b32 v92, v11, v92
    v_add_f32 v52, v52, v53
    v_cvt_pk_bf16_f32 v94, v44, v48
    v_add_f32 v56, v56, v57
    v_cvt_pk_bf16_f32 v95, v52, v56
    buffer_store_dwordx4 v[92:95], v13, s[16:19], s48 offen sc1
    s_mov_b64 exec, -1
    v_alignbit_b32 v26, v6, v6, 10
    s_add_u32 m0, s58, 5120
    s_mov_b32 s60, 5120
    v_bitop3_b32 v26, v1, v26, s37 bitop3:0x78
    buffer_load_dwordx4 v26, s[32:35], s60 offen  lds
    v_alignbit_b32 v26, v6, v6, 12
    s_add_u32 m0, s58, 6144
    s_mov_b32 s60, 6144
    v_bitop3_b32 v26, v1, v26, s37 bitop3:0x78
    buffer_load_dwordx4 v26, s[32:35], s60 offen  lds
    v_alignbit_b32 v26, v6, v6, 14
    s_add_u32 m0, s58, 7168
    s_mov_b32 s60, 7168
    v_bitop3_b32 v26, v1, v26, s37 bitop3:0x78
    buffer_load_dwordx4 v26, s[32:35], s60 offen  lds
    v_alignbit_b32 v26, v6, v6, 16
    s_add_u32 m0, s58, 8192
    s_mov_b32 s60, 8192
    v_bitop3_b32 v26, v1, v26, s37 bitop3:0x78
    buffer_load_dwordx4 v26, s[32:35], s60 offen  lds
    v_alignbit_b32 v26, v6, v6, 18
    s_add_u32 m0, s58, 9216
    s_mov_b32 s60, 9216
    v_bitop3_b32 v26, v1, v26, s37 bitop3:0x78
    buffer_load_dwordx4 v26, s[32:35], s60 offen  lds
    v_alignbit_b32 v26, v6, v6, 20
    s_add_u32 m0, s58, 10240
    s_mov_b32 s60, 10240
    v_bitop3_b32 v26, v1, v26, s37 bitop3:0x78
    buffer_load_dwordx4 v26, s[32:35], s60 offen  lds
    v_alignbit_b32 v26, v6, v6, 22
    s_add_u32 m0, s58, 11264
    s_mov_b32 s60, 11264
    v_bitop3_b32 v26, v1, v26, s37 bitop3:0x78
    buffer_load_dwordx4 v26, s[32:35], s60 offen  lds
    v_alignbit_b32 v26, v6, v6, 24
    s_add_u32 m0, s58, 12288
    s_mov_b32 s60, 12288
    v_bitop3_b32 v26, v1, v26, s37 bitop3:0x78
    buffer_load_dwordx4 v26, s[32:35], s60 offen  lds
    v_alignbit_b32 v26, v6, v6, 26
    s_add_u32 m0, s58, 13312
    s_mov_b32 s60, 13312
    v_bitop3_b32 v26, v1, v26, s37 bitop3:0x78
    buffer_load_dwordx4 v26, s[32:35], s60 offen  lds
    v_mov_b32 v25, 0xffff0000
    v_cndmask_b32 v25, 0, v25, s[100:101]
    v_mov_b64 v[32:33], 0
    v_mov_b64 v[36:37], 0
    v_mov_b64 v[40:41], 0
    v_mov_b64 v[44:45], 0
    v_mov_b64 v[48:49], 0
    v_mov_b64 v[52:53], 0
    v_mov_b64 v[56:57], 0
    v_mov_b64 v[60:61], 0
    v_mov_b64 v[108:109], 0
    s_lshl_b32 s59, s3, 3
    s_add_u32 s59, s59, 159744
    v_mov_b32 v31, s59
    v_mov_b32 v30, 159744
    s_mov_b32 s52, 0
    s_mov_b32 s53, 0x80000000
    v_mov_b32 v28, 0x3727c5ac
    buffer_load_dword v16, v3, s[16:19], 0 offen offset:0 sc1
    buffer_load_dword v17, v4, s[16:19], 0 offen offset:0 sc1
    s_waitcnt vmcnt(11)
    buffer_load_dwordx4 v[64:67], v13, s[16:19], s40 offen sc1
    buffer_load_dwordx4 v[68:71], v13, s[16:19], s41 offen sc1
    buffer_load_dwordx4 v[72:75], v13, s[16:19], s42 offen sc1
    buffer_load_dwordx4 v[76:79], v13, s[16:19], s43 offen sc1
    buffer_load_dwordx4 v[80:83], v13, s[16:19], s44 offen sc1
    buffer_load_dwordx4 v[84:87], v13, s[16:19], s45 offen sc1
    buffer_load_dwordx4 v[88:91], v13, s[16:19], s46 offen sc1
    s_mov_b64 exec, s[100:101]
    buffer_load_dwordx4 v[92:95], v14, s[16:19], s47 offen sc1
    s_mov_b64 exec, -1
    s_waitcnt vmcnt(10)
    s_barrier
    s_add_u32 s59, s36, 57344
    v_xad_u32 v27, v2, s59, v9
    ds_read_b64_tr_b16 a[0:1], v27 offset:0
    ds_read_b64_tr_b16 a[2:3], v27 offset:3584
    ds_read_b64_tr_b16 a[4:5], v27 offset:28672
    ds_read_b64_tr_b16 a[6:7], v27 offset:32256
    s_add_u32 s59, s36, 57376
    v_xad_u32 v27, v2, s59, v9
    ds_read_b64_tr_b16 a[8:9], v27 offset:0
    ds_read_b64_tr_b16 a[10:11], v27 offset:3584
    ds_read_b64_tr_b16 a[12:13], v27 offset:28672
    ds_read_b64_tr_b16 a[14:15], v27 offset:32256
    s_add_u32 s59, s36, 57408
    v_xad_u32 v27, v2, s59, v9
    ds_read_b64_tr_b16 a[16:17], v27 offset:0
    ds_read_b64_tr_b16 a[18:19], v27 offset:3584
    ds_read_b64_tr_b16 a[20:21], v27 offset:28672
    ds_read_b64_tr_b16 a[22:23], v27 offset:32256
    s_add_u32 s59, s36, 57440
    v_xad_u32 v27, v2, s59, v9
    ds_read_b64_tr_b16 a[24:25], v27 offset:0
    ds_read_b64_tr_b16 a[26:27], v27 offset:3584
    ds_read_b64_tr_b16 a[28:29], v27 offset:28672
    ds_read_b64_tr_b16 a[30:31], v27 offset:32256
    s_add_u32 s59, s36, 57472
    v_xad_u32 v27, v2, s59, v9
    ds_read_b64_tr_b16 a[32:33], v27 offset:0
    ds_read_b64_tr_b16 a[34:35], v27 offset:3584
    ds_read_b64_tr_b16 a[36:37], v27 offset:28672
    ds_read_b64_tr_b16 a[38:39], v27 offset:32256
    s_add_u32 s59, s36, 57504
    v_xad_u32 v27, v2, s59, v9
    ds_read_b64_tr_b16 a[40:41], v27 offset:0
    ds_read_b64_tr_b16 a[42:43], v27 offset:3584
    ds_read_b64_tr_b16 a[44:45], v27 offset:28672
    ds_read_b64_tr_b16 a[46:47], v27 offset:32256
    s_add_u32 s59, s36, 57536
    v_xad_u32 v27, v2, s59, v9
    ds_read_b64_tr_b16 a[48:49], v27 offset:0
    ds_read_b64_tr_b16 a[50:51], v27 offset:3584
    ds_read_b64_tr_b16 a[52:53], v27 offset:28672
    ds_read_b64_tr_b16 a[54:55], v27 offset:32256
    s_waitcnt vmcnt(0)
L_g_top_27:
    v_xor_b32 v24, v11, v64
    v_bitop3_b32 v24, v24, v68, v11 bitop3:0xf6
    v_bitop3_b32 v24, v24, v72, v11 bitop3:0xf6
    v_bitop3_b32 v24, v24, v76, v11 bitop3:0xf6
    v_bitop3_b32 v24, v24, v80, v11 bitop3:0xf6
    v_bitop3_b32 v24, v24, v84, v11 bitop3:0xf6
    v_bitop3_b32 v24, v24, v88, v11 bitop3:0xf6
    v_bitop3_b32 v24, v24, v92, v11 bitop3:0xf6
    v_bitop3_b32 v24, v24, v16, v29 bitop3:0xf6
    v_bitop3_b32 v24, v24, v17, v29 bitop3:0xf6
    v_cmp_ne_u16 vcc, 0, v24
    s_cbranch_vccz L_g_out_28
    v_cmp_ne_u16 vcc, v11, v64
    s_cbranch_vccz L_g_skip_29
    buffer_load_dwordx4 v[64:67], v13, s[16:19], s40 offen sc1
L_g_skip_29:
    v_cmp_ne_u16 vcc, v11, v68
    s_cbranch_vccz L_g_skip_30
    buffer_load_dwordx4 v[68:71], v13, s[16:19], s41 offen sc1
L_g_skip_30:
    v_cmp_ne_u16 vcc, v11, v72
    s_cbranch_vccz L_g_skip_31
    buffer_load_dwordx4 v[72:75], v13, s[16:19], s42 offen sc1
L_g_skip_31:
    v_cmp_ne_u16 vcc, v11, v76
    s_cbranch_vccz L_g_skip_32
    buffer_load_dwordx4 v[76:79], v13, s[16:19], s43 offen sc1
L_g_skip_32:
    v_cmp_ne_u16 vcc, v11, v80
    s_cbranch_vccz L_g_skip_33
    buffer_load_dwordx4 v[80:83], v13, s[16:19], s44 offen sc1
L_g_skip_33:
    v_cmp_ne_u16 vcc, v11, v84
    s_cbranch_vccz L_g_skip_34
    buffer_load_dwordx4 v[84:87], v13, s[16:19], s45 offen sc1
L_g_skip_34:
    v_cmp_ne_u16 vcc, v11, v88
    s_cbranch_vccz L_g_skip_35
    buffer_load_dwordx4 v[88:91], v13, s[16:19], s46 offen sc1
L_g_skip_35:
    v_cmp_ne_u16 vcc, v11, v92
    s_cbranch_vccz L_g_skip_36
    s_mov_b64 exec, s[100:101]
    buffer_load_dwordx4 v[92:95], v14, s[16:19], s47 offen sc1
    s_mov_b64 exec, -1
L_g_skip_36:
    v_xor_b32 v24, v29, v16
    v_bitop3_b32 v24, v24, v17, v29 bitop3:0xf6
    v_cmp_ne_u16 vcc, 0, v24
    s_cbranch_vccz L_g_skip_37
    buffer_load_dword v16, v3, s[16:19], 0 offen offset:0 sc1
    buffer_load_dword v17, v4, s[16:19], 0 offen offset:0 sc1
L_g_skip_37:
    s_add_u32 s92, s92, 1
    s_cmp_gt_u32 s92, 1048576
    s_cbranch_scc1 L_g_giveup_38
    s_and_b32 s63, s92, 63
    s_cbranch_scc1 L_nowb_39
    s_waitcnt vmcnt(0)
    buffer_wbl2 sc1
L_nowb_39:
    s_waitcnt vmcnt(0)
    s_branch L_g_top_27
L_g_giveup_38:
    s_waitcnt vmcnt(0)
L_g_out_28:
    v_smfmac_f32_16x16x64_bf16 v[108:111], v[124:127], v[64:71], v10 abid:1
    v_smfmac_f32_16x16x64_bf16 v[108:111], v[124:127], v[72:79], v10 abid:1
    v_smfmac_f32_16x16x64_bf16 v[108:111], v[124:127], v[80:87], v10 abid:1
    v_smfmac_f32_16x16x64_bf16 v[108:111], v[124:127], v[88:95], v10 abid:1
    v_and_b32 v16, v25, v16
    v_and_b32 v17, 0xffff0000, v17
    s_nop 5
    v_fma_f32 v108, v108, v16, v18
    v_fma_f32 v109, v109, v17, v19
    v_mul_f32 v24, v108, v20
    v_mul_f32 v25, v109, v21
    v_cvt_pk_bf16_f32 v112, v24, v25
    v_add_f32 v110, v108, v109
    v_mul_f32 v111, v108, v108
    v_mov_b32_dpp v113, v112 row_ror:14 row_mask:0xf bank_mask:0xf
    v_mov_b32_dpp v114, v112 row_ror:12 row_mask:0xf bank_mask:0xf
    v_mov_b32_dpp v115, v112 row_ror:10 row_mask:0xf bank_mask:0xf
    v_fmac_f32 v111, v109, v109
    v_mov_b32_dpp v116, v112 row_ror:8 row_mask:0xf bank_mask:0xf
    v_smfmac_f32_16x16x64_bf16 v[32:35], v[112:115], v[128:135], v10
    v_mov_b32_dpp v117, v112 row_ror:6 row_mask:0xf bank_mask:0xf
    v_mov_b32_dpp v118, v112 row_ror:4 row_mask:0xf bank_mask:0xf
    v_smfmac_f32_16x16x64_bf16 v[48:51], v[112:115], v[192:199], v10
    v_mov_b32_dpp v119, v112 row_ror:2 row_mask:0xf bank_mask:0xf
    v_smfmac_f32_16x16x64_bf16 v[36:39], v[112:115], v[144:151], v10
    v_add_f32_dpp v110, v110, v110 row_ror:8 row_mask:0xf bank_mask:0xf
    v_add_f32_dpp v111, v111, v111 row_ror:8 row_mask:0xf bank_mask:0xf
    v_smfmac_f32_16x16x64_bf16 v[52:55], v[112:115], v[208:215], v10
    v_add_f32_dpp v110, v110, v110 row_ror:4 row_mask:0xf bank_mask:0xf
    v_add_f32_dpp v111, v111, v111 row_ror:4 row_mask:0xf bank_mask:0xf
    v_smfmac_f32_16x16x64_bf16 v[40:43], v[112:115], v[160:167], v10
    v_add_f32_dpp v110, v110, v110 row_ror:2 row_mask:0xf bank_mask:0xf
    v_add_f32_dpp v111, v111, v111 row_ror:2 row_mask:0xf bank_mask:0xf
    v_smfmac_f32_16x16x64_bf16 v[56:59], v[112:115], v[224:231], v10
    v_add_f32_dpp v110, v110, v110 row_ror:1 row_mask:0xf bank_mask:0xf
    v_add_f32_dpp v111, v111, v111 row_ror:1 row_mask:0xf bank_mask:0xf
    v_smfmac_f32_16x16x64_bf16 v[44:47], v[112:115], v[176:183], v10
    v_add_f32_dpp v110, v110, v110 row_bcast:15 row_mask:0xa bank_mask:0xf
    v_add_f32_dpp v111, v111, v111 row_bcast:15 row_mask:0xa bank_mask:0xf
    v_smfmac_f32_16x16x64_bf16 v[60:63], v[112:115], v[240:247], v10
    v_add_f32_dpp v110, v110, v110 row_bcast:31 row_mask:0xc bank_mask:0xf
    v_add_f32_dpp v111, v111, v111 row_bcast:31 row_mask:0xc bank_mask:0xf
    v_smfmac_f32_16x16x64_bf16 v[32:35], v[116:119], v[136:143], v10
    s_mov_b64 exec, s[52:53]
    ds_write_b64 v31, v[110:111]
    s_mov_b64 exec, 0xffff
    v_smfmac_f32_16x16x64_bf16 v[48:51], v[116:119], v[200:207], v10
    v_mov_b64 v[72:73], 0
    v_mov_b64 v[76:77], 0
    v_smfmac_f32_16x16x64_bf16 v[36:39], v[116:119], v[152:159], v10
    v_mov_b64 v[80:81], 0
    v_mov_b64 v[84:85], 0
    v_smfmac_f32_16x16x64_bf16 v[52:55], v[116:119], v[216:223], v10
    v_mov_b64 v[88:89], 0
    v_mov_b64 v[92:93], 0
    v_smfmac_f32_16x16x64_bf16 v[40:43], v[116:119], v[168:175], v10
    v_mov_b64 v[96:97], 0
    v_smfmac_f32_16x16x64_bf16 v[56:59], v[116:119], v[232:239], v10
    v_smfmac_f32_16x16x64_bf16 v[44:47], v[116:119], v[184:191], v10
    v_smfmac_f32_16x16x64_bf16 v[60:63], v[116:119], v[248:255], v10
    v_add_f32 v64, v32, v33
    v_add_f32 v65, v48, v49
    v_add_f32 v66, v36, v37
    v_add_f32 v67, v52, v53
    ds_write_b128 v22, v[64:67]
    v_add_f32 v68, v40, v41
    v_add_f32 v69, v56, v57
    v_add_f32 v70, v44, v45
    v_add_f32 v71, v60, v61
    ds_write_b128 v22, v[68:71] offset:16
    s_mov_b64 exec, -1
    s_waitcnt lgkmcnt(0)
    s_barrier
    ds_read_b128 v[40:43], v30
    ds_read_b128 v[44:47], v30 offset:16
    ds_read2st64_b64 v[32:35], v23 offset0:0 offset1:1
    ds_read2st64_b64 v[36:39], v23 offset0:2 offset1:3
    s_waitcnt lgkmcnt(3)
    v_pk_add_f32 v[40:41], v[40:41], v[42:43]
    s_waitcnt lgkmcnt(2)
    v_pk_add_f32 v[44:45], v[44:45], v[46:47]
    v_pk_add_f32 v[40:41], v[40:41], v[44:45]
    v_mul_f32 v40, 0x3b124925, v40
    v_mul_f32 v41, 0x3b124925, v41
    v_fma_f32 v41, -v40, v40, v41
    s_waitcnt lgkmcnt(1)
    v_max_f32 v41, 0, v41
    v_pk_add_f32 v[32:33], v[32:33], v[34:35]
    v_add_f32 v41, v28, v41
    v_rsq_f32 v41, v41
    s_waitcnt lgkmcnt(0)
    v_pk_add_f32 v[36:37], v[36:37], v[38:39]
    v_pk_add_f32 v[32:33], v[32:33], v[36:37]
    v_fma_f32 v32, -v40, v120, v32
    v_fma_f32 v33, -v40, v121, v33
    v_fma_f32 v32, v41, v32, v122
    v_fma_f32 v33, v41, v33, v123
    v_mul_f32 v34, 0xbfb8aa3b, v32
    v_exp_f32 v34, v34
    v_mul_f32 v32, v32, v33
    v_add_f32 v34, 1.0, v34
    v_rcp_f32 v34, v34
    s_nop 0
    v_mul_f32 v32, v32, v34
    s_nop 1
    v_mov_b32_dpp v33, v32 quad_perm:[2,3,0,1] row_mask:0xf bank_mask:0xf
    v_cvt_pk_bf16_f32 v112, v32, v33
    s_nop 1
    v_mov_b32_dpp v113, v112 row_ror:12 row_mask:0xf bank_mask:0xf
    v_mov_b32_dpp v114, v112 row_ror:8 row_mask:0xf bank_mask:0xf
    v_mov_b32_dpp v115, v112 row_ror:4 row_mask:0xf bank_mask:0xf
    s_nop 1
    v_smfmac_f32_16x16x64_bf16 v[72:75], v[112:115], a[0:7], v10
    v_smfmac_f32_16x16x64_bf16 v[76:79], v[112:115], a[8:15], v10
    v_smfmac_f32_16x16x64_bf16 v[80:83], v[112:115], a[16:23], v10
    v_smfmac_f32_16x16x64_bf16 v[84:87], v[112:115], a[24:31], v10
    v_smfmac_f32_16x16x64_bf16 v[88:91], v[112:115], a[32:39], v10
    v_smfmac_f32_16x16x64_bf16 v[92:95], v[112:115], a[40:47], v10
    v_smfmac_f32_16x16x64_bf16 v[96:99], v[112:115], a[48:55], v10
    s_mov_b64 exec, 0xffff
    s_nop 0
    v_add_f32 v72, v72, v73
    v_add_f32 v76, v76, v77
    v_add_f32 v80, v80, v81
    v_cvt_pk_bf16_f32 v104, 0, v72
    v_add_f32 v84, v84, v85
    v_cvt_pk_bf16_f32 v105, v76, v80
    v_add_f32 v88, v88, v89
    v_or_b32 v104, v11, v104
    v_add_f32 v92, v92, v93
    v_cvt_pk_bf16_f32 v106, v84, v88
    v_add_f32 v96, v96, v97
    v_cvt_pk_bf16_f32 v107, v92, v96
    buffer_store_dwordx4 v[104:107], v13, s[16:19], s49 offen sc1
    s_mov_b64 exec, -1
    s_lshl2_add_u32 s59, s2, s3
    v_add_u32 v24, s59, v0
    v_lshlrev_b32 v24, 21, v24
    v_add_u32 v24, 980992, v24
    v_mov_b32 v25, s88
    buffer_store_dword v25, v24, s[16:19], 0 offen sc1
    s_endpgm
    .p2align 6
L_progI:
    v_lshrrev_b32 v1, 6, v0
    v_and_b32 v0, 63, v0
    v_readfirstlane_b32 s3, v1
    s_and_b32 s4, s2, 7
    s_and_b32 s5, s61, 3
    s_lshr_b32 s6, s2, 5
    s_mov_b32 s92, 0
    v_lshlrev_b32 v1, 4, v0
    s_mul_i32 s57, s3, 14336
    s_add_u32 s58, s57, 57344
    s_lshl2_add_u32 s93, s6, s7
    s_sub_u32 s93, s93, 28
    s_lshl1_add_u32 s60, s93, -41
    s_min_i32 s60, s60, 20
    s_add_u32 s59, s93, 7
    s_cmp_lt_u32 s93, 28
    s_cselect_b32 s59, s59, s60
    s_cmp_lt_u32 s93, 14
    s_cselect_b32 s24, s93, s59
    s_lshl_b32 s59, s24, 7
    s_mul_i32 s60, s3, 602112
    s_add_u32 s59, s59, s60
    s_mov_b32 s22, 596864
    s_mov_b32 s23, 0x20000
    s_max_u32 s62, s93, 7
    s_min_u32 s62, s62, 13
    s_sub_u32 s62, s62, 7
    v_lshrrev_b32 v28, 3, v0
    v_mul_u32_u24 v28, 5376, v28
    v_and_b32 v29, 7, v0
    v_lshl_add_u32 v7, v29, 4, v28
    v_mul_u32_u24 v28, 896, v29
    v_mov_b32 v65, v28
    v_lshrrev_b32 v29, 4, v0
    v_lshl_add_u32 v28, v29, 3, v28
    s_lshl2_add_u32 s62, s62, s3
    s_lshl_b32 s62, s62, 5
    v_add_u32 v66, s62, v28
    s_mul_i32 s62, s3, 224
    v_add_u32 v28, s62, v28
    v_and_b32 v29, 8, v0
    v_lshl_add_u32 v29, v29, 2, v28
    s_waitcnt lgkmcnt(0)
    s_add_u32 s20, s84, s59
    s_addc_u32 s21, s85, 0
    global_load_dwordx2 v[32:33], v29, s[82:83] offset:0
    global_load_dwordx2 v[34:35], v29, s[82:83] offset:64
    global_load_dwordx2 v[36:37], v29, s[82:83] offset:128
    global_load_dwordx2 v[38:39], v28, s[82:83] offset:192
    s_add_u32 m0, s58, 0
    s_mov_b32 s60, 0
    buffer_load_dwordx4 v7, s[20:23], s60 offen  lds
    s_add_u32 m0, s58, 1024
    s_mov_b32 s60, 43008
    buffer_load_dwordx4 v7, s[20:23], s60 offen  lds
    s_max_u32 s59, s93, 20
    s_sub_u32 s59, s59, 20
    s_lshr_b32 s61, s59, 2
    s_and_b32 s59, s59, 3
    s_lshl2_add_u32 s59, s3, s59
    s_mul_i32 s59, s59, 150528
    s_lshl_b32 s61, s61, 8
    s_add_u32 s59, s59, s61
    s_cmp_ge_u32 s93, 20
    s_cselect_b32 s61, 5376, 0
    v_min_u32 v24, 27, v0
    v_mul_u32_u24 v24, s61, v24
    v_add_u32 v24, s59, v24
    global_load_dword v119, v24, s[84:85] offset:1792
    s_add_u32 m0, s58, 2048
    s_mov_b32 s60, 86016
    buffer_load_dwordx4 v7, s[20:23], s60 offen  lds
    s_add_u32 m0, s58, 3072
    s_mov_b32 s60, 129024
    buffer_load_dwordx4 v7, s[20:23], s60 offen  lds
    s_add_u32 m0, s58, 4096
    s_mov_b32 s60, 172032
    buffer_load_dwordx4 v7, s[20:23], s60 offen  lds
    s_add_u32 m0, s58, 5120
    s_mov_b32 s60, 215040
    buffer_load_dwordx4 v7, s[20:23], s60 offen  lds
    global_load_dwordx2 v[40:41], v29, s[64:65] offset:0
    global_load_dwordx2 v[42:43], v29, s[64:65] offset:64
    global_load_dwordx2 v[44:45], v29, s[64:65] offset:128
    global_load_dwordx2 v[46:47], v28, s[64:65] offset:192
    global_load_ushort v64, v65, s[64:65]
    global_load_dwordx2 v[66:67], v66, s[64:65]
    s_add_u32 m0, s58, 6144
    s_mov_b32 s60, 258048
    buffer_load_dwordx4 v7, s[20:23], s60 offen  lds
    s_add_u32 m0, s58, 7168
    s_mov_b32 s60, 301056
    buffer_load_dwordx4 v7, s[20:23], s60 offen  lds
    v_lshrrev_b32 v2, 5, v0
    v_xor_b32 v2, v2, v0
    v_lshlrev_b32 v2, 4, v2
    s_lshl_b32 s59, s3, 5
    v_xor_b32 v24, s59, v0
    v_and_b32 v24, 32, v24
    v_lshl_add_u32 v2, v24, 11, v2
    s_lshl3_add_u32 s59, s6, s4
    s_lshl2_add_u32 s59, s59, 3
    s_lshl_b32 s59, s59, 20
    s_lshl_b32 s60, s3, 3
    s_lshr_b32 s60, 0xcd61ac00, s60
    s_lshl_b32 s61, s5, 3
    s_lshr_b32 s61, 0x2b86ad00, s61
    s_xor_b32 s60, s60, s61
    s_and_b32 s60, s60, 0xff
    s_lshl_b32 s40, s60, 12
    s_mul_i32 s56, s3, 8448
    s_add_u32 s56, s56, 114688
    s_mov_b32 s10, 0x100000
    s_mov_b32 s11, 0x20000
    s_mov_b32 s14, 0x100000
    s_mov_b32 s15, 0x20000
    s_add_u32 s8, s66, s59
    s_addc_u32 s9, s67, 0
    s_add_u32 s12, s68, s59
    s_addc_u32 s13, s69, 0
    s_mov_b32 s16, s90
    s_mov_b32 s17, s91
    s_mov_b32 s18, 1572864
    s_mov_b32 s19, 0x20000
    s_load_dword s88, s[90:91], 980992
    s_mov_b32 s94, 0x00ff00ff
    s_mov_b32 s95, s94
    s_not_b64 s[98:99], s[94:95]
    v_lshrrev_b32 v24, 2, v0
    v_and_b32 v25, 3, v0
    v_lshlrev_b32 v25, 3, v25
    v_lshl_add_u32 v24, v24, 7, v25
    v_add_u32 v8, s58, v24
    s_waitcnt vmcnt(15)
    v_lshlrev_b32 v80, 16, v32
    v_and_b32 v81, 0xffff0000, v32
    v_lshlrev_b32 v82, 16, v33
    v_and_b32 v83, 0xffff0000, v33
    v_mul_f32 v84, 0xbfb8aa3b, v80
    v_mul_f32 v85, 0xbfb8aa3b, v81
    v_mul_f32 v86, 0xbfb8aa3b, v82
    v_mul_f32 v87, 0xbfb8aa3b, v83
    v_exp_f32 v84, v84
    v_exp_f32 v85, v85
    v_exp_f32 v86, v86
    v_exp_f32 v87, v87
    v_add_f32 v84, 1.0, v84
    v_min_f32 v84, 0x7f000000, v84
    v_add_f32 v85, 1.0, v85
    v_min_f32 v85, 0x7f000000, v85
    v_add_f32 v86, 1.0, v86
    v_min_f32 v86, 0x7f000000, v86
    v_add_f32 v87, 1.0, v87
    v_min_f32 v87, 0x7f000000, v87
    v_rcp_f32 v88, v84
    v_rcp_f32 v89, v85
    v_rcp_f32 v90, v86
    v_rcp_f32 v91, v87
    v_mul_f32 v92, v80, v88
    v_mul_f32 v93, v81, v89
    v_mul_f32 v94, v82, v90
    v_mul_f32 v95, v83, v91
    v_fma_f32 v80, -v92, v84, v80
    v_fmac_f32 v92, v80, v88
    v_fma_f32 v81, -v93, v85, v81
    v_fmac_f32 v93, v81, v89
    v_fma_f32 v82, -v94, v86, v82
    v_fmac_f32 v94, v82, v90
    v_fma_f32 v83, -v95, v87, v83
    v_fmac_f32 v95, v83, v91
    v_cvt_pk_bf16_f32 v128, v92, v93
    v_cvt_pk_bf16_f32 v129, v94, v95
    s_nop 0
    v_mov_b32_dpp v130, v128 row_ror:8 row_mask:0xf bank_mask:0xf
    v_mov_b32_dpp v131, v129 row_ror:8 row_mask:0xf bank_mask:0xf
    s_waitcnt vmcnt(14)
    s_add_u32 m0, s58, 8192
    s_mov_b32 s60, 344064
    buffer_load_dwordx4 v7, s[20:23], s60 offen  lds
    v_lshlrev_b32 v80, 16, v34
    v_and_b32 v81, 0xffff0000, v34
    v_lshlrev_b32 v82, 16, v35
    v_and_b32 v83, 0xffff0000, v35
    v_mul_f32 v84, 0xbfb8aa3b, v80
    v_mul_f32 v85, 0xbfb8aa3b, v81
    v_mul_f32 v86, 0xbfb8aa3b, v82
    v_mul_f32 v87, 0xbfb8aa3b, v83
    v_exp_f32 v84, v84
    v_exp_f32 v85, v85
    v_exp_f32 v86, v86
    v_exp_f32 v87, v87
    v_add_f32 v84, 1.0, v84
    v_min_f32 v84, 0x7f000000, v84
    v_add_f32 v85, 1.0, v85
    v_min_f32 v85, 0x7f000000, v85
    v_add_f32 v86, 1.0, v86
    v_min_f32 v86, 0x7f000000, v86
    v_add_f32 v87, 1.0, v87
    v_min_f32 v87, 0x7f000000, v87
    v_rcp_f32 v88, v84
    v_rcp_f32 v89, v85
    v_rcp_f32 v90, v86
    v_rcp_f32 v91, v87
    v_mul_f32 v92, v80, v88
    v_mul_f32 v93, v81, v89
    v_mul_f32 v94, v82, v90
    v_mul_f32 v95, v83, v91
    v_fma_f32 v80, -v92, v84, v80
    v_fmac_f32 v92, v80, v88
    v_fma_f32 v81, -v93, v85, v81
    v_fmac_f32 v93, v81, v89
    v_fma_f32 v82, -v94, v86, v82
    v_fmac_f32 v94, v82, v90
    v_fma_f32 v83, -v95, v87, v83
    v_fmac_f32 v95, v83, v91
    v_cvt_pk_bf16_f32 v132, v92, v93
    v_cvt_pk_bf16_f32 v133, v94, v95
    s_nop 0
    v_mov_b32_dpp v134, v132 row_ror:8 row_mask:0xf bank_mask:0xf
    v_mov_b32_dpp v135, v133 row_ror:8 row_mask:0xf bank_mask:0xf
    s_waitcnt vmcnt(14)
    s_add_u32 m0, s58, 9216
    s_mov_b32 s60, 387072
    buffer_load_dwordx4 v7, s[20:23], s60 offen  lds
    v_lshlrev_b32 v80, 16, v36
    v_and_b32 v81, 0xffff0000, v36
    v_lshlrev_b32 v82, 16, v37
    v_and_b32 v83, 0xffff0000, v37
    v_mul_f32 v84, 0xbfb8aa3b, v80
    v_mul_f32 v85, 0xbfb8aa3b, v81
    v_mul_f32 v86, 0xbfb8aa3b, v82
    v_mul_f32 v87, 0xbfb8aa3b, v83
    v_exp_f32 v84, v84
    v_exp_f32 v85, v85
    v_exp_f32 v86, v86
    v_exp_f32 v87, v87
    v_add_f32 v84, 1.0, v84
    v_min_f32 v84, 0x7f000000, v84
    v_add_f32 v85, 1.0, v85
    v_min_f32 v85, 0x7f000000, v85
    v_add_f32 v86, 1.0, v86
    v_min_f32 v86, 0x7f000000, v86
    v_add_f32 v87, 1.0, v87
    v_min_f32 v87, 0x7f000000, v87
    v_rcp_f32 v88, v84
    v_rcp_f32 v89, v85
    v_rcp_f32 v90, v86
    v_rcp_f32 v91, v87
    v_mul_f32 v92, v80, v88
    v_mul_f32 v93, v81, v89
    v_mul_f32 v94, v82, v90
    v_mul_f32 v95, v83, v91
    v_fma_f32 v80, -v92, v84, v80
    v_fmac_f32 v92, v80, v88
    v_fma_f32 v81, -v93, v85, v81
    v_fmac_f32 v93, v81, v89
    v_fma_f32 v82, -v94, v86, v82
    v_fmac_f32 v94, v82, v90
    v_fma_f32 v83, -v95, v87, v83
    v_fmac_f32 v95, v83, v91
    v_cvt_pk_bf16_f32 v136, v92, v93
    v_cvt_pk_bf16_f32 v137, v94, v95
    s_nop 0
    v_mov_b32_dpp v138, v136 row_ror:8 row_mask:0xf bank_mask:0xf
    v_mov_b32_dpp v139, v137 row_ror:8 row_mask:0xf bank_mask:0xf
    ds_read_b64_tr_b16 v[144:145], v8 offset:0
    ds_read_b64_tr_b16 v[146:147], v8 offset:32
    ds_read_b64_tr_b16 v[148:149], v8 offset:64
    ds_read_b64_tr_b16 v[150:151], v8 offset:96
    s_waitcnt vmcnt(13)
    s_add_u32 m0, s58, 10240
    s_mov_b32 s60, 430080
    buffer_load_dwordx4 v7, s[20:23], s60 offen  lds
    v_lshlrev_b32 v80, 16, v38
    v_and_b32 v81, 0xffff0000, v38
    v_lshlrev_b32 v82, 16, v39
    v_and_b32 v83, 0xffff0000, v39
    v_mul_f32 v84, 0xbfb8aa3b, v80
    v_mul_f32 v85, 0xbfb8aa3b, v81
    v_mul_f32 v86, 0xbfb8aa3b, v82
    v_mul_f32 v87, 0xbfb8aa3b, v83
    v_exp_f32 v84, v84
    v_exp_f32 v85, v85
    v_exp_f32 v86, v86
    v_exp_f32 v87, v87
    v_add_f32 v84, 1.0, v84
    v_min_f32 v84, 0x7f000000, v84
    v_add_f32 v85, 1.0, v85
    v_min_f32 v85, 0x7f000000, v85
    v_add_f32 v86, 1.0, v86
    v_min_f32 v86, 0x7f000000, v86
    v_add_f32 v87, 1.0, v87
    v_min_f32 v87, 0x7f000000, v87
    v_rcp_f32 v88, v84
    v_rcp_f32 v89, v85
    v_rcp_f32 v90, v86
    v_rcp_f32 v91, v87
    v_mul_f32 v92, v80, v88
    v_mul_f32 v93, v81, v89
    v_mul_f32 v94, v82, v90
    v_mul_f32 v95, v83, v91
    v_fma_f32 v80, -v92, v84, v80
    v_fmac_f32 v92, v80, v88
    v_fma_f32 v81, -v93, v85, v81
    v_fmac_f32 v93, v81, v89
    v_fma_f32 v82, -v94, v86, v82
    v_fmac_f32 v94, v82, v90
    v_fma_f32 v83, -v95, v87, v83
    v_fmac_f32 v95, v83, v91
    v_cvt_pk_bf16_f32 v140, v92, v93
    v_cvt_pk_bf16_f32 v141, v94, v95
    s_waitcnt vmcnt(13)
    s_add_u32 m0, s58, 11264
    s_mov_b32 s60, 473088
    buffer_load_dwordx4 v7, s[20:23], s60 offen  lds
    s_waitcnt lgkmcnt(0)
    v_mfma_f32_16x16x16_bf16 v[160:163], v[144:145], v[128:129], 0
    v_mfma_f32_16x16x16_bf16 v[164:167], v[146:147], v[128:129], 0
    v_mfma_f32_16x16x16_bf16 v[168:171], v[148:149], v[128:129], 0
    v_mfma_f32_16x16x16_bf16 v[172:175], v[150:151], v[128:129], 0
    ds_read_b64_tr_b16 v[152:153], v8 offset:2048
    ds_read_b64_tr_b16 v[154:155], v8 offset:2080
    ds_read_b64_tr_b16 v[156:157], v8 offset:2112
    ds_read_b64_tr_b16 v[158:159], v8 offset:2144
    s_waitcnt vmcnt(13)
    s_add_u32 m0, s58, 12288
    s_mov_b32 s60, 516096
    buffer_load_dwordx4 v7, s[20:23], s60 offen  lds
    s_waitcnt vmcnt(7)
    v_lshlrev_b32 v64, 16, v64
    v_mov_b32 v68, 0
    v_mov_b32 v69, 0
    v_lshlrev_b32 v24, 16, v40
    v_and_b32 v25, 0xffff0000, v40
    v_lshlrev_b32 v26, 16, v41
    v_and_b32 v27, 0xffff0000, v41
    v_sub_f32 v24, v24, v64
    v_sub_f32 v25, v25, v64
    v_sub_f32 v26, v26, v64
    v_sub_f32 v27, v27, v64
    v_add_f32 v68, v68, v24
    v_fmac_f32 v69, v24, v24
    v_add_f32 v68, v68, v25
    v_fmac_f32 v69, v25, v25
    v_add_f32 v68, v68, v26
    v_fmac_f32 v69, v26, v26
    v_add_f32 v68, v68, v27
    v_fmac_f32 v69, v27, v27
    s_add_u32 m0, s58, 13312
    s_mov_b32 s60, 559104
    buffer_load_dwordx4 v7, s[20:23], s60 offen  lds
    s_waitcnt lgkmcnt(0)
    v_mfma_f32_16x16x16_bf16 v[160:163], v[152:153], v[130:131], v[160:163]
    v_mfma_f32_16x16x16_bf16 v[164:167], v[154:155], v[130:131], v[164:167]
    v_mfma_f32_16x16x16_bf16 v[168:171], v[156:157], v[130:131], v[168:171]
    v_mfma_f32_16x16x16_bf16 v[172:175], v[158:159], v[130:131], v[172:175]
    ds_read_b64_tr_b16 v[144:145], v8 offset:4096
    ds_read_b64_tr_b16 v[146:147], v8 offset:4128
    ds_read_b64_tr_b16 v[148:149], v8 offset:4160
    ds_read_b64_tr_b16 v[150:151], v8 offset:4192
    v_lshlrev_b32 v24, 16, v42
    v_and_b32 v25, 0xffff0000, v42
    v_lshlrev_b32 v26, 16, v43
    v_and_b32 v27, 0xffff0000, v43
    v_sub_f32 v24, v24, v64
    v_sub_f32 v25, v25, v64
    v_sub_f32 v26, v26, v64
    v_sub_f32 v27, v27, v64
    v_add_f32 v68, v68, v24
    v_fmac_f32 v69, v24, v24
    v_add_f32 v68, v68, v25
    v_fmac_f32 v69, v25, v25
    v_add_f32 v68, v68, v26
    v_fmac_f32 v69, v26, v26
    v_add_f32 v68, v68, v27
    v_fmac_f32 v69, v27, v27
    s_waitcnt vmcnt(7)
    s_mov_b32 m0, s56
    s_xor_b32 s41, s40, 0xab000
    buffer_load_dwordx4 v2, s[8:11], s40 offen offset:0 nt lds
    v_lshlrev_b32 v24, 16, v44
    v_and_b32 v25, 0xffff0000, v44
    v_lshlrev_b32 v26, 16, v45
    v_and_b32 v27, 0xffff0000, v45
    v_sub_f32 v24, v24, v64
    v_sub_f32 v25, v25, v64
    v_sub_f32 v26, v26, v64
    v_sub_f32 v27, v27, v64
    v_add_f32 v68, v68, v24
    v_fmac_f32 v69, v24, v24
    v_add_f32 v68, v68, v25
    v_fmac_f32 v69, v25, v25
    v_add_f32 v68, v68, v26
    v_fmac_f32 v69, v26, v26
    v_add_f32 v68, v68, v27
    v_fmac_f32 v69, v27, v27
    s_lshl2_add_u32 s62, s5, s3
    s_lshl2_add_u32 s63, s2, s3
    v_mov_b32 v24, 1073741824
    s_lshl3_add_u32 s59, s4, s6
    s_lshl4_add_u32 s59, s59, s62
    s_lshl_b32 s59, s59, 9
    s_mov_b64 exec, 0xf
    v_mov_b32 v24, s59
    s_mul_i32 s59, s63, 384
    s_add_u32 s59, s59, 524288
    s_mov_b64 exec, 0x70
    v_mov_b32 v24, s59
    s_lshl3_add_u32 s59, s6, s4
    s_lshl2_add_u32 s59, s59, s5
    s_lshl_b32 s59, s59, 7
    s_add_u32 s59, s59, 917504
    s_mov_b64 exec, 0x100
    v_mov_b32 v24, s59
    s_mov_b64 exec, 0xfffff
    v_and_b32 v25, 3, v0
    v_lshl_add_u32 v24, v25, 7, v24
    buffer_load_dword v119, v24, s[16:19], 0 offen sc1
    s_mov_b64 exec, -1
    s_waitcnt vmcnt(8)
    s_add_u32 m0, s56, 32
    s_nop 0
    buffer_load_dwordx4 v2, s[8:11], s40 offen offset:1024 nt lds
    s_waitcnt lgkmcnt(0)
    v_mfma_f32_16x16x16_bf16 v[160:163], v[144:145], v[132:133], v[160:163]
    v_mfma_f32_16x16x16_bf16 v[164:167], v[146:147], v[132:133], v[164:167]
    v_mfma_f32_16x16x16_bf16 v[168:171], v[148:149], v[132:133], v[168:171]
    v_mfma_f32_16x16x16_bf16 v[172:175], v[150:151], v[132:133], v[172:175]
    ds_read_b64_tr_b16 v[152:153], v8 offset:6144
    ds_read_b64_tr_b16 v[154:155], v8 offset:6176
    ds_read_b64_tr_b16 v[156:157], v8 offset:6208
    ds_read_b64_tr_b16 v[158:159], v8 offset:6240
    s_mov_b64 exec, s[94:95]
    v_lshlrev_b32 v24, 16, v46
    v_and_b32 v25, 0xffff0000, v46
    v_lshlrev_b32 v26, 16, v47
    v_and_b32 v27, 0xffff0000, v47
    v_sub_f32 v24, v24, v64
    v_sub_f32 v25, v25, v64
    v_sub_f32 v26, v26, v64
    v_sub_f32 v27, v27, v64
    v_add_f32 v68, v68, v24
    v_fmac_f32 v69, v24, v24
    v_add_f32 v68, v68, v25
    v_fmac_f32 v69, v25, v25
    v_add_f32 v68, v68, v26
    v_fmac_f32 v69, v26, v26
    v_add_f32 v68, v68, v27
    v_fmac_f32 v69, v27, v27
    s_mov_b64 exec, -1
    v_add_f32_dpp v68, v68, v68 row_ror:8 row_mask:0xf bank_mask:0xf
    v_mov_b32 v24, v68
    s_nop 1
    v_permlane16_swap_b32 v68, v24
    v_add_f32 v68, v68, v24
    v_mov_b32 v24, v68
    s_nop 1
    v_permlane32_swap_b32 v68, v24
    v_add_f32 v68, v68, v24
    v_add_f32_dpp v69, v69, v69 row_ror:8 row_mask:0xf bank_mask:0xf
    v_mov_b32 v24, v69
    s_nop 1
    v_permlane16_swap_b32 v69, v24
    v_add_f32 v69, v69, v24
    v_mov_b32 v24, v69
    s_nop 1
    v_permlane32_swap_b32 v69, v24
    v_add_f32 v69, v69, v24
    s_lshl_b32 s59, s3, 6
    s_add_u32 s59, s59, 159744
    v_and_b32 v24, 7, v0
    v_lshl_add_u32 v25, v24, 3, s59
    ds_write_b64 v25, v[68:69]
    v_lshlrev_b32 v24, 3, v24
    v_add_u32 v24, 159744, v24
    s_waitcnt lgkmcnt(0)
    s_barrier
    ds_read_b64 v[80:81], v24 offset:0
    ds_read_b64 v[82:83], v24 offset:64
    ds_read_b64 v[84:85], v24 offset:128
    ds_read_b64 v[86:87], v24 offset:192
    s_waitcnt vmcnt(8)
    s_add_u32 m0, s56, 64
    s_nop 0
    buffer_load_dwordx4 v2, s[8:11], s40 offen offset:2048 nt lds
    s_waitcnt vmcnt(8)
    s_add_u32 m0, s56, 96
    s_nop 0
    buffer_load_dwordx4 v2, s[8:11], s40 offen offset:3072 nt lds
    s_waitcnt lgkmcnt(0)
    v_mfma_f32_16x16x16_bf16 v[160:163], v[152:153], v[134:135], v[160:163]
    v_mfma_f32_16x16x16_bf16 v[164:167], v[154:155], v[134:135], v[164:167]
    v_mfma_f32_16x16x16_bf16 v[168:171], v[156:157], v[134:135], v[168:171]
    v_mfma_f32_16x16x16_bf16 v[172:175], v[158:159], v[134:135], v[172:175]
    ds_read_b64_tr_b16 v[144:145], v8 offset:8192
    ds_read_b64_tr_b16 v[146:147], v8 offset:8224
    ds_read_b64_tr_b16 v[148:149], v8 offset:8256
    ds_read_b64_tr_b16 v[150:151], v8 offset:8288
    s_waitcnt lgkmcnt(0)
    v_add_f32 v80, v80, v82
    v_add_f32 v81, v81, v83
    v_add_f32 v84, v84, v86
    v_add_f32 v85, v85, v87
    v_add_f32 v80, v80, v84
    v_add_f32 v81, v81, v85
    v_mul_f32 v80, 0x3b124925, v80
    v_mul_f32 v81, 0x3b124925, v81
    v_add_f32 v82, v64, v80
    v_fma_f32 v83, -v80, v80, v81
    v_max_f32 v83, 0, v83
    v_cvt_pk_bf16_f32 v82, 0, v82
    v_cvt_pk_bf16_f32 v83, 0, v83
    v_add_f32 v83, 0x3727c5ac, v83
    v_cvt_pk_bf16_f32 v83, 0, v83
    v_sqrt_f32 v83, v83
    s_nop 0
    v_cvt_pk_bf16_f32 v83, 0, v83
    v_rcp_f32 v84, v83
    v_lshlrev_b32 v176, 16, v66
    v_and_b32 v177, 0xffff0000, v66
    v_lshlrev_b32 v178, 16, v67
    v_and_b32 v179, 0xffff0000, v67
    v_sub_f32 v176, v176, v82
    v_cvt_pk_bf16_f32 v176, 0, v176
    v_mul_f32 v88, v176, v84
    v_fma_f32 v89, -v88, v83, v176
    v_fma_f32 v176, v89, v84, v88
    v_cvt_pk_bf16_f32 v176, 0, v176
    v_sub_f32 v177, v177, v82
    v_cvt_pk_bf16_f32 v177, 0, v177
    v_mul_f32 v88, v177, v84
    v_fma_f32 v89, -v88, v83, v177
    v_fma_f32 v177, v89, v84, v88
    v_cvt_pk_bf16_f32 v177, 0, v177
    v_sub_f32 v178, v178, v82
    v_cvt_pk_bf16_f32 v178, 0, v178
    v_mul_f32 v88, v178, v84
    v_fma_f32 v89, -v88, v83, v178
    v_fma_f32 v178, v89, v84, v88
    v_cvt_pk_bf16_f32 v178, 0, v178
    v_sub_f32 v179, v179, v82
    v_cvt_pk_bf16_f32 v179, 0, v179
    v_mul_f32 v88, v179, v84
    v_fma_f32 v89, -v88, v83, v179
    v_fma_f32 v179, v89, v84, v88
    v_cvt_pk_bf16_f32 v179, 0, v179
    s_waitcnt vmcnt(8)
    s_add_u32 m0, s56, 4224
    s_xor_b32 s42, s40, 0x8000
    buffer_load_dwordx4 v2, s[8:11], s41 offen offset:0 nt lds
    s_waitcnt lgkmcnt(0)
    s_and_b32 s59, s88, 0x7f7f7f7f
    s_add_u32 s59, s59, 0x01010101
    s_and_b32 s88, s88, 0x80808080
    s_xor_b32 s88, s88, s59
    s_and_b32 s89, s88, 0xffff
    s_lshr_b32 s1, s88, 16
    s_waitcnt vmcnt(8)
    s_add_u32 m0, s56, 4256
    s_nop 0
    buffer_load_dwordx4 v2, s[8:11], s41 offen offset:1024 nt lds
    s_waitcnt lgkmcnt(0)
    v_mfma_f32_16x16x16_bf16 v[160:163], v[144:145], v[136:137], v[160:163]
    v_mfma_f32_16x16x16_bf16 v[164:167], v[146:147], v[136:137], v[164:167]
    v_mfma_f32_16x16x16_bf16 v[168:171], v[148:149], v[136:137], v[168:171]
    v_mfma_f32_16x16x16_bf16 v[172:175], v[150:151], v[136:137], v[172:175]
    ds_read_b64_tr_b16 v[152:153], v8 offset:10240
    ds_read_b64_tr_b16 v[154:155], v8 offset:10272
    ds_read_b64_tr_b16 v[156:157], v8 offset:10304
    ds_read_b64_tr_b16 v[158:159], v8 offset:10336
    s_waitcnt vmcnt(8)
    s_add_u32 m0, s56, 4288
    s_nop 0
    buffer_load_dwordx4 v2, s[8:11], s41 offen offset:2048 nt lds
    s_mul_i32 s59, s5, 917504
    s_lshl_b32 s60, s4, 10
    s_add_u32 s59, s59, s60
    s_lshl_b32 s60, s6, 7
    s_add_u32 s59, s59, s60
    s_add_u32 s36, s70, s59
    s_addc_u32 s37, s71, 0
    s_mov_b32 s38, 909440
    s_mov_b32 s39, 0x20000
    v_lshrrev_b32 v24, 3, v0
    v_and_b32 v25, 7, v0
    v_lshlrev_b32 v25, 4, v25
    v_lshl_add_u32 v24, v24, 13, v25
    s_lshl_b32 s59, s3, 18
    v_add_u32 v5, s59, v24
    s_lshr_b32 s59, s6, 2
    s_lshl_b32 s59, s59, 16
    v_xor_b32 v5, s59, v5
    s_lshl_b32 s59, s6, 8
    s_and_b32 s59, s59, 1024
    s_xor_b32 s59, s59, 0
    s_add_u32 s59, s59, s57
    s_add_u32 m0, s59, 8448
    s_nop 0
    buffer_load_dwordx4 v5, s[36:39], 0 offen  lds
    v_xor_b32 v5, 0x10000, v5
    s_lshl_b32 s59, s6, 8
    s_and_b32 s59, s59, 1024
    s_xor_b32 s59, s59, 1024
    s_add_u32 s59, s59, s57
    s_add_u32 m0, s59, 8448
    s_nop 0
    buffer_load_dwordx4 v5, s[36:39], 0 offen  lds
    v_xor_b32 v5, 0x30000, v5
    s_lshl_b32 s59, s6, 8
    s_and_b32 s59, s59, 1024
    s_xor_b32 s59, s59, 2048
    s_add_u32 s59, s59, s57
    s_add_u32 m0, s59, 8448
    s_nop 0
    buffer_load_dwordx4 v5, s[36:39], 0 offen  lds
    v_xor_b32 v5, 0x10000, v5
    s_lshl_b32 s59, s6, 8
    s_and_b32 s59, s59, 1024
    s_xor_b32 s59, s59, 3072
    s_add_u32 s59, s59, s57
    s_add_u32 m0, s59, 8448
    s_nop 0
    buffer_load_dwordx4 v5, s[36:39], 0 offen  lds
    s_waitcnt vmcnt(12)
    s_add_u32 m0, s56, 4320
    s_nop 0
    buffer_load_dwordx4 v2, s[8:11], s41 offen offset:3072 nt lds
    s_waitcnt lgkmcnt(0)
    v_mfma_f32_16x16x16_bf16 v[160:163], v[152:153], v[138:139], v[160:163]
    v_mfma_f32_16x16x16_bf16 v[164:167], v[154:155], v[138:139], v[164:167]
    v_mfma_f32_16x16x16_bf16 v[168:171], v[156:157], v[138:139], v[168:171]
    v_mfma_f32_16x16x16_bf16 v[172:175], v[158:159], v[138:139], v[172:175]
    ds_read_b64_tr_b16 v[144:145], v8 offset:12288
    ds_read_b64_tr_b16 v[146:147], v8 offset:12320
    ds_read_b64_tr_b16 v[148:149], v8 offset:12352
    ds_read_b64_tr_b16 v[150:151], v8 offset:12384
    v_lshrrev_b32 v24, 4, v0
    v_and_b32 v25, 7, v0
    v_lshlrev_b32 v25, 4, v25
    v_lshl_add_u32 v24, v24, 7, v25
    v_add_u32 v25, s58, v24
    s_lshl_b32 s59, s3, 9
    v_add_u32 v24, s59, v24
    v_and_b32 v26, 15, v0
    v_and_b32 v27, 16, v0
    v_lshl_add_u32 v26, v26, 7, v27
    s_lshl_b32 s59, s3, 5
    v_add_u32 v26, s59, v26
    s_cmp_lt_u32 s93, 14
    s_cselect_b64 vcc, -1, 0
    v_cndmask_b32 v24, v26, v24, vcc
    v_add_u32 v180, 57344, v24
    s_waitcnt lgkmcnt(0)
    v_mfma_f32_16x16x16_bf16 v[160:163], v[144:145], v[140:141], v[160:163]
    v_mfma_f32_16x16x16_bf16 v[164:167], v[146:147], v[140:141], v[164:167]
    v_mfma_f32_16x16x16_bf16 v[168:171], v[148:149], v[140:141], v[168:171]
    v_mfma_f32_16x16x16_bf16 v[172:175], v[150:151], v[140:141], v[172:175]
    s_mov_b64 exec, s[94:95]
    s_nop 3
    ds_write_b128 v25, v[160:163] offset:0
    ds_write_b128 v25, v[164:167] offset:512
    ds_write_b128 v25, v[168:171] offset:1024
    ds_write_b128 v25, v[172:175] offset:1536
    s_mov_b64 exec, -1
    s_waitcnt lgkmcnt(0)
    s_barrier
    ds_read_b128 v[160:163], v180 offset:0
    ds_read_b128 v[164:167], v180 offset:14336
    ds_read_b128 v[168:171], v180 offset:28672
    ds_read_b128 v[172:175], v180 offset:43008
    s_lshl_b32 s60, s24, 8
    s_mul_i32 s61, s3, 14336
    s_add_u32 s60, s60, s61
    s_add_u32 s60, s60, 979456
    v_lshrrev_b32 v24, 4, v0
    v_mul_u32_u24 v24, 7168, v24
    v_and_b32 v25, 15, v0
    v_lshl_add_u32 v24, v25, 4, v24
    v_add_u32 v24, s60, v24
    v_mov_b32 v26, 1073741824
    v_cmp_gt_u32 vcc, 32, v0
    s_nop 1
    v_cndmask_b32 v25, v26, v24, vcc
    s_lshl2_add_u32 s59, s93, s3
    s_lshl_b32 s59, s59, 9
    s_add_u32 s59, s59, 950272
    v_and_b32 v24, 48, v0
    v_and_b32 v27, 7, v0
    v_lshlrev_b32 v27, 4, v27
    v_lshl_add_u32 v24, v24, 3, v27
    v_add_u32 v24, s59, v24
    v_cndmask_b32 v24, v26, v24, s[94:95]
    s_cmp_lt_u32 s93, 14
    s_cselect_b64 vcc, -1, 0
    v_cndmask_b32 v25, v25, v24, vcc
    s_waitcnt lgkmcnt(0)
    v_add_f32 v160, v160, v164
    v_add_f32 v168, v168, v172
    v_add_f32 v161, v161, v165
    v_add_f32 v169, v169, v173
    v_add_f32 v162, v162, v166
    v_add_f32 v170, v170, v174
    v_add_f32 v163, v163, v167
    v_add_f32 v171, v171, v175
    v_add_f32 v160, v160, v168
    v_add_f32 v161, v161, v169
    v_add_f32 v162, v162, v170
    v_add_f32 v163, v163, v171
    s_sub_u32 s59, s93, 7
    s_cmp_lt_u32 s59, 7
    s_cbranch_scc0 L_sa_1001
    v_cvt_pk_bf16_f32 v160, 0, v160
    v_cvt_pk_bf16_f32 v161, 0, v161
    v_cvt_pk_bf16_f32 v162, 0, v162
    v_cvt_pk_bf16_f32 v163, 0, v163
    v_add_f32 v160, 1.0, v160
    v_add_f32 v161, 1.0, v161
    v_add_f32 v162, 1.0, v162
    v_add_f32 v163, 1.0, v163
    v_cvt_pk_bf16_f32 v160, 0, v160
    v_cvt_pk_bf16_f32 v161, 0, v161
    v_cvt_pk_bf16_f32 v162, 0, v162
    v_cvt_pk_bf16_f32 v163, 0, v163
    v_mul_f32 v160, v176, v160
    v_mul_f32 v161, v177, v161
    v_mul_f32 v162, v178, v162
    v_mul_f32 v163, v179, v163
L_sa_1001:
    v_cvt_pk_bf16_f32 v160, 0, v160
    v_cvt_pk_bf16_f32 v161, 0, v161
    v_cvt_pk_bf16_f32 v162, 0, v162
    v_cvt_pk_bf16_f32 v163, 0, v163
    v_or_b32 v160, s89, v160
    v_or_b32 v161, s1, v161
    v_or_b32 v162, s89, v162
    v_or_b32 v163, s1, v163
    buffer_store_dwordx4 v[160:163], v25, s[16:19], 0 offen sc1
    s_waitcnt vmcnt(13)
    s_mov_b32 m0, s57
    s_xor_b32 s43, s40, 0xa3000
    buffer_load_dwordx4 v2, s[8:11], s42 offen offset:0 nt lds
    s_waitcnt vmcnt(12)
    s_add_u32 m0, s57, 32
    s_nop 0
    buffer_load_dwordx4 v2, s[8:11], s42 offen offset:1024 nt lds
    v_bfe_u32 v24, v0, 1, 1
    v_bfe_u32 v25, v0, 2, 2
    v_lshl_add_u32 v24, v24, 2, v25
    v_mul_u32_u24 v24, 1056, v24
    v_and_b32 v25, 1, v0
    v_lshl_add_u32 v24, v25, 9, v24
    v_lshrrev_b32 v26, 4, v0
    v_xor_b32 v26, v26, v25
    v_lshl_add_u32 v24, v26, 4, v24
    v_add_u32 v3, s56, v24
    v_add_u32 v4, s57, v24
    s_waitcnt vmcnt(12)
    s_add_u32 m0, s57, 64
    s_nop 0
    buffer_load_dwordx4 v2, s[8:11], s42 offen offset:2048 nt lds
    s_waitcnt vmcnt(12)
    s_add_u32 m0, s57, 96
    s_nop 0
    buffer_load_dwordx4 v2, s[8:11], s42 offen offset:3072 nt lds
    s_waitcnt vmcnt(12)
    s_add_u32 m0, s57, 4224
    s_xor_b32 s44, s40, 0xe5000
    buffer_load_dwordx4 v2, s[8:11], s43 offen offset:0 nt lds
    s_waitcnt vmcnt(12)
    s_add_u32 m0, s57, 4256
    s_nop 0
    buffer_load_dwordx4 v2, s[8:11], s43 offen offset:1024 nt lds
    s_waitcnt vmcnt(12)
    s_add_u32 m0, s57, 4288
    s_nop 0
    buffer_load_dwordx4 v2, s[8:11], s43 offen offset:2048 nt lds
    v_and_b32 v24, 1, v0
    v_lshlrev_b32 v24, 4, v24
    v_mov_b32 v25, 0xffff
    v_lshlrev_b32 v24, v24, v25
    v_and_b32 v25, 2, v0
    v_cmp_eq_u32 vcc, 0, v25
    s_nop 1
    v_cndmask_b32 v10, 0, v24, vcc
    v_cndmask_b32 v11, v24, 0, vcc
    v_bfe_u32 v24, v0, 4, 1
    v_and_b32 v25, 7, v0
    v_lshlrev_b32 v25, 5, v25
    v_lshl_add_u32 v24, v24, 8, v25
    v_lshrrev_b32 v25, 5, v0
    v_lshl_add_u32 v12, v25, 4, v24
    s_waitcnt vmcnt(8)
    s_add_u32 m0, s57, 4320
    s_nop 0
    buffer_load_dwordx4 v2, s[8:11], s43 offen offset:3072 nt lds
    ds_read_b128 a[0:3], v3 offset:0
    ds_read_b128 a[4:7], v3 offset:64
    ds_read_b128 a[8:11], v3 offset:128
    ds_read_b128 a[12:15], v3 offset:192
    ds_read_b128 a[16:19], v3 offset:256
    ds_read_b128 a[20:23], v3 offset:320
    ds_read_b128 a[24:27], v3 offset:384
    ds_read_b128 a[28:31], v3 offset:448
    s_waitcnt lgkmcnt(0)
    s_waitcnt vmcnt(7)
    s_mov_b32 m0, s56
    s_xor_b32 s45, s40, 0x4e000
    buffer_load_dwordx4 v2, s[8:11], s44 offen offset:0 nt lds
    s_waitcnt vmcnt(7)
    s_add_u32 m0, s56, 32
    s_nop 0
    buffer_load_dwordx4 v2, s[8:11], s44 offen offset:1024 nt lds
    s_waitcnt vmcnt(7)
    s_add_u32 m0, s56, 64
    s_nop 0
    buffer_load_dwordx4 v2, s[8:11], s44 offen offset:2048 nt lds
    v_lshrrev_b32 v24, 4, v0
    v_bfe_u32 v25, v0, 2, 2
    v_lshl_add_u32 v24, v24, 3, v25
    v_mul_u32_u24 v24, 896, v24
    v_and_b32 v25, 3, v0
    v_lshl_add_u32 v9, v25, 3, v24
    s_mov_b64 exec, 0xff
    v_mov_b32 v6, 0xd7d20a01
    s_lshl_b64 exec, exec, 8
    v_mov_b32 v6, 0xd7d20a01
    s_lshl_b64 exec, exec, 8
    v_mov_b32 v6, 0xf7d28a01
    s_lshl_b64 exec, exec, 8
    v_mov_b32 v6, 0xf7d28a01
    s_lshl_b64 exec, exec, 8
    v_mov_b32 v6, 0xf5d28201
    s_lshl_b64 exec, exec, 8
    v_mov_b32 v6, 0xf5d28201
    s_lshl_b64 exec, exec, 8
    v_mov_b32 v6, 0xf5f28281
    s_lshl_b64 exec, exec, 8
    v_mov_b32 v6, 0xf5f28281
    s_mov_b64 exec, -1
    v_bfe_u32 v24, v0, 3, 1
    v_lshrrev_b32 v25, 4, v0
    v_lshlrev_b32 v25, 6, v25
    v_lshl_add_u32 v24, v24, 8, v25
    v_and_b32 v25, 7, v0
    v_lshl_add_u32 v24, v25, 3, v24
    v_add_u32 v15, 157696, v24
    s_lshl2_add_u32 s59, s6, s3
    s_lshl_b32 s59, s59, 13
    v_add_u32 v13, s59, v1
    s_waitcnt vmcnt(7)
    s_add_u32 m0, s56, 96
    s_nop 0
    buffer_load_dwordx4 v2, s[8:11], s44 offen offset:3072 nt lds
    s_lshl_b32 s59, s4, 9
    s_lshl_b32 s60, s5, 6
    s_add_u32 s59, s59, s60
    s_mul_i32 s59, s59, 896
    s_add_u32 s59, s59, s57
    s_add_u32 s28, s72, s59
    s_addc_u32 s29, s73, 0
    s_mov_b32 s30, 243712
    s_mov_b32 s31, 0x20000
    s_waitcnt vmcnt(7)
    s_add_u32 m0, s56, 4224
    s_xor_b32 s46, s40, 0xed000
    buffer_load_dwordx4 v2, s[8:11], s45 offen offset:0 nt lds
    s_waitcnt vmcnt(7)
    s_add_u32 m0, s56, 4256
    s_nop 0
    buffer_load_dwordx4 v2, s[8:11], s45 offen offset:1024 nt lds
    s_waitcnt vmcnt(7)
    s_add_u32 m0, s56, 4288
    s_nop 0
    buffer_load_dwordx4 v2, s[8:11], s45 offen offset:2048 nt lds
    s_waitcnt vmcnt(7)
    s_add_u32 m0, s56, 4320
    s_nop 0
    buffer_load_dwordx4 v2, s[8:11], s45 offen offset:3072 nt lds
    ds_read_b128 a[32:35], v4 offset:0
    ds_read_b128 a[36:39], v4 offset:64
    ds_read_b128 a[40:43], v4 offset:128
    ds_read_b128 a[44:47], v4 offset:192
    ds_read_b128 a[48:51], v4 offset:256
    ds_read_b128 a[52:55], v4 offset:320
    ds_read_b128 a[56:59], v4 offset:384
    ds_read_b128 a[60:63], v4 offset:448
    s_lshl2_add_u32 s59, s5, s3
    s_mul_i32 s59, s59, 896
    s_add_u32 s59, s59, 950272
    v_min_u32 v90, 55, v0
    v_lshl_add_u32 v88, v90, 4, s59
    v_add_u32 v89, 14336, v88
    s_mul_i32 s60, s3, 448
    s_add_u32 s60, s60, 148480
    v_lshl_add_u32 v90, v90, 3, s60
    buffer_load_dwordx4 v[80:83], v88, s[16:19], 0 offen sc1
    buffer_load_dwordx4 v[84:87], v89, s[16:19], 0 offen sc1
    s_waitcnt lgkmcnt(0)
    s_waitcnt vmcnt(9)
    s_mov_b32 m0, s57
    s_xor_b32 s47, s40, 0x46000
    buffer_load_dwordx4 v2, s[8:11], s46 offen offset:0 nt lds
    s_waitcnt vmcnt(9)
    s_add_u32 m0, s57, 32
    s_nop 0
    buffer_load_dwordx4 v2, s[8:11], s46 offen offset:1024 nt lds
    s_waitcnt vmcnt(9)
    s_add_u32 m0, s57, 64
    s_nop 0
    buffer_load_dwordx4 v2, s[8:11], s46 offen offset:2048 nt lds
    s_waitcnt vmcnt(9)
    s_add_u32 m0, s57, 96
    s_nop 0
    buffer_load_dwordx4 v2, s[8:11], s46 offen offset:3072 nt lds
    s_waitcnt vmcnt(9)
    s_add_u32 m0, s57, 4224
    s_xor_b32 s48, s40, 0x8d000
    buffer_load_dwordx4 v2, s[8:11], s47 offen offset:0 nt lds
    s_waitcnt vmcnt(9)
    s_add_u32 m0, s57, 4256
    s_nop 0
    buffer_load_dwordx4 v2, s[8:11], s47 offen offset:1024 nt lds
    s_waitcnt vmcnt(9)
    s_add_u32 m0, s57, 4288
    s_nop 0
    buffer_load_dwordx4 v2, s[8:11], s47 offen offset:2048 nt lds
    s_waitcnt vmcnt(9)
    s_add_u32 m0, s57, 4320
    s_nop 0
    buffer_load_dwordx4 v2, s[8:11], s47 offen offset:3072 nt lds
    ds_read_b128 a[64:67], v3 offset:0
    ds_read_b128 a[68:71], v3 offset:64
    ds_read_b128 a[72:75], v3 offset:128
    ds_read_b128 a[76:79], v3 offset:192
    ds_read_b128 a[80:83], v3 offset:256
    ds_read_b128 a[84:87], v3 offset:320
    ds_read_b128 a[88:91], v3 offset:384
    ds_read_b128 a[92:95], v3 offset:448
    s_waitcnt lgkmcnt(0)
    s_waitcnt vmcnt(7)
    s_mov_b32 m0, s56
    s_xor_b32 s49, s40, 0x26000
    buffer_load_dwordx4 v2, s[8:11], s48 offen offset:0 nt lds
L_h_chk_1002:
    v_xor_b32 v80, s89, v80
    v_xor_b32 v81, s1, v81
    v_xor_b32 v82, s89, v82
    v_xor_b32 v83, s1, v83
    v_xor_b32 v84, s89, v84
    v_xor_b32 v85, s1, v85
    v_xor_b32 v86, s89, v86
    v_xor_b32 v87, s1, v87
    v_or3_b32 v91, v80, v81, v82
    v_or3_b32 v91, v91, v83, v84
    v_or3_b32 v91, v91, v85, v86
    v_or_b32 v91, v91, v87
    v_and_b32 v91, 0xffff, v91
    v_cmp_ne_u32 vcc, 0, v91
    s_cbranch_vccz L_h_ok_1003
    buffer_load_dwordx4 v[80:83], v88, s[16:19], 0 offen sc1
    buffer_load_dwordx4 v[84:87], v89, s[16:19], 0 offen sc1
    s_add_u32 s92, s92, 1
    s_cmp_gt_u32 s92, 1048576
    s_cbranch_scc1 L_h_giveup_1004
    s_and_b32 s63, s92, 63
    s_cbranch_scc1 L_nowb_1005
    s_waitcnt vmcnt(0)
    buffer_wbl2 sc1
L_nowb_1005:
    s_waitcnt vmcnt(0)
    s_branch L_h_chk_1002
L_h_giveup_1004:
    s_waitcnt vmcnt(0)
L_h_ok_1003:
    v_add_f32 v80, v80, v84
    v_add_f32 v81, v81, v85
    v_add_f32 v82, v82, v86
    v_add_f32 v83, v83, v87
    v_cvt_pk_bf16_f32 v80, v80, v81
    v_cvt_pk_bf16_f32 v81, v82, v83
    ds_write_b64 v90, v[80:81]
    v_lshrrev_b32 v96, 2, v0
    v_and_b32 v97, 3, v0
    v_lshlrev_b32 v97, 3, v97
    v_lshl_add_u32 v96, v96, 7, v97
    s_lshl_b32 s59, s3, 5
    v_add_u32 v96, s59, v96
    v_lshrrev_b32 v97, 4, v0
    v_and_b32 v26, 7, v0
    v_lshlrev_b32 v26, 3, v26
    v_lshl_add_u32 v97, v97, 6, v26
    v_add_u32 v97, 148480, v97
    s_waitcnt vmcnt(7)
    s_add_u32 m0, s56, 32
    s_nop 0
    buffer_load_dwordx4 v2, s[8:11], s48 offen offset:1024 nt lds
    s_waitcnt lgkmcnt(0)
    s_barrier
    ds_read_b64_tr_b16 v[32:33], v96 offset:8448
    ds_read_b64 v[48:49], v97 offset:0
    ds_read_b64_tr_b16 v[34:35], v96 offset:10496
    ds_read_b64 v[50:51], v97 offset:256
    ds_read_b64_tr_b16 v[36:37], v96 offset:22784
    ds_read_b64 v[52:53], v97 offset:512
    ds_read_b64_tr_b16 v[38:39], v96 offset:24832
    ds_read_b64 v[54:55], v97 offset:768
    ds_read_b64_tr_b16 v[40:41], v96 offset:37120
    ds_read_b64 v[56:57], v97 offset:1024
    ds_read_b64_tr_b16 v[42:43], v96 offset:39168
    ds_read_b64 v[58:59], v97 offset:1280
    ds_read_b64_tr_b16 v[44:45], v96 offset:51456
    ds_read_b64 v[60:61], v97 offset:1536
    s_waitcnt vmcnt(7)
    s_add_u32 m0, s56, 64
    s_nop 0
    buffer_load_dwordx4 v2, s[8:11], s48 offen offset:2048 nt lds
    s_waitcnt lgkmcnt(0)
    v_mfma_f32_16x16x32_bf16 v[80:83], v[48:51], v[32:35], 0
    v_mfma_f32_16x16x32_bf16 v[80:83], v[52:55], v[36:39], v[80:83]
    v_mfma_f32_16x16x32_bf16 v[80:83], v[56:59], v[40:43], v[80:83]
    s_lshl_b32 s59, s4, 16
    s_lshl_b32 s60, s5, 11
    s_add_u32 s59, s59, s60
    s_lshl2_add_u32 s60, s6, s3
    s_lshl_b32 s60, s60, 6
    s_add_u32 s59, s59, s60
    s_add_u32 s60, s59, 0x2000
    v_mfma_f32_16x16x16_bf16 v[80:83], v[60:61], v[44:45], v[80:83]
    v_and_b32 v26, 16, v0
    v_lshlrev_b32 v26, 11, v26
    v_and_b32 v27, 32, v0
    v_lshl_add_u32 v26, v27, 9, v26
    v_and_b32 v27, 15, v0
    v_lshl_add_u32 v26, v27, 2, v26
    v_lshlrev_b32 v27, 1, v27
    v_lshrrev_b32 v27, v27, s88
    v_cmp_lt_u32 vcc, 31, v0
    s_nop 1
    v_cndmask_b32 v80, v80, v82, vcc
    v_bfi_b32 v80, 3, v27, v80
    v_cndmask_b32 v81, v81, v83, vcc
    v_bfi_b32 v81, 3, v27, v81
    buffer_store_dword v80, v26, s[16:19], s59 offen offset:0
    buffer_store_dword v81, v26, s[16:19], s60 offen offset:0
    s_waitcnt vmcnt(9)
    s_add_u32 m0, s56, 96
    s_nop 0
    buffer_load_dwordx4 v2, s[8:11], s48 offen offset:3072 nt lds
    s_waitcnt vmcnt(9)
    s_add_u32 m0, s56, 4224
    s_xor_b32 s50, s40, 0x85000
    buffer_load_dwordx4 v2, s[8:11], s49 offen offset:0 nt lds
    s_waitcnt vmcnt(9)
    s_add_u32 m0, s56, 4256
    s_nop 0
    buffer_load_dwordx4 v2, s[8:11], s49 offen offset:1024 nt lds
    s_waitcnt vmcnt(9)
    s_add_u32 m0, s56, 4288
    s_nop 0
    buffer_load_dwordx4 v2, s[8:11], s49 offen offset:2048 nt lds
    s_waitcnt vmcnt(9)
    s_add_u32 m0, s56, 4320
    s_nop 0
    buffer_load_dwordx4 v2, s[8:11], s49 offen offset:3072 nt lds
    ds_read_b128 a[96:99], v4 offset:0
    ds_read_b128 a[100:103], v4 offset:64
    ds_read_b128 a[104:107], v4 offset:128
    ds_read_b128 a[108:111], v4 offset:192
    ds_read_b128 a[112:115], v4 offset:256
    ds_read_b128 a[116:119], v4 offset:320
    ds_read_b128 a[120:123], v4 offset:384
    ds_read_b128 a[124:127], v4 offset:448
    s_waitcnt lgkmcnt(0)
    s_waitcnt vmcnt(9)
    s_mov_b32 m0, s57
    s_xor_b32 s51, s40, 0x2e000
    buffer_load_dwordx4 v2, s[8:11], s50 offen offset:0 nt lds
    s_waitcnt vmcnt(9)
    s_add_u32 m0, s57, 32
    s_nop 0
    buffer_load_dwordx4 v2, s[8:11], s50 offen offset:1024 nt lds
    s_waitcnt vmcnt(9)
    s_add_u32 m0, s57, 64
    s_nop 0
    buffer_load_dwordx4 v2, s[8:11], s50 offen offset:2048 nt lds
    s_waitcnt vmcnt(7)
    s_add_u32 m0, s57, 96
    s_nop 0
    buffer_load_dwordx4 v2, s[8:11], s50 offen offset:3072 nt lds
    s_waitcnt vmcnt(7)
    s_add_u32 m0, s57, 4224
    s_xor_b32 s52, s40, 0x68000
    buffer_load_dwordx4 v2, s[8:11], s51 offen offset:0 nt lds
    s_waitcnt vmcnt(7)
    s_add_u32 m0, s57, 4256
    s_nop 0
    buffer_load_dwordx4 v2, s[8:11], s51 offen offset:1024 nt lds
    s_waitcnt vmcnt(7)
    s_add_u32 m0, s57, 4288
    s_nop 0
    buffer_load_dwordx4 v2, s[8:11], s51 offen offset:2048 nt lds
    s_waitcnt vmcnt(7)
    s_add_u32 m0, s57, 4320
    s_nop 0
    buffer_load_dwordx4 v2, s[8:11], s51 offen offset:3072 nt lds
    ds_read_b128 a[128:131], v3 offset:0
    ds_read_b128 a[132:135], v3 offset:64
    ds_read_b128 a[136:139], v3 offset:128
    ds_read_b128 a[140:143], v3 offset:192
    ds_read_b128 a[144:147], v3 offset:256
    ds_read_b128 a[148:151], v3 offset:320
    ds_read_b128 a[152:155], v3 offset:384
    ds_read_b128 a[156:159], v3 offset:448
    s_waitcnt lgkmcnt(0)
    s_waitcnt vmcnt(7)
    s_mov_b32 m0, s56
    s_xor_b32 s53, s40, 0xc3000
    buffer_load_dwordx4 v2, s[8:11], s52 offen offset:0 nt lds
    s_lshl_b32 s59, s4, 16
    s_lshl_b32 s60, s6, 13
    s_add_u32 s59, s59, s60
    s_lshl_b32 s60, s3, 9
    s_add_u32 s59, s59, s60
    v_lshrrev_b32 v92, 5, v0
    v_lshlrev_b32 v92, 11, v92
    v_and_b32 v93, 31, v0
    v_lshlrev_b32 v93, 4, v93
    v_add3_u32 v92, v92, v93, s59
    v_add_u32 v93, 0x1000, v92
    buffer_load_dwordx4 v[84:87], v92, s[16:19], 0 offen sc1
    buffer_load_dwordx4 v[88:91], v93, s[16:19], 0 offen sc1
    s_waitcnt vmcnt(9)
    s_add_u32 m0, s56, 32
    s_nop 0
    buffer_load_dwordx4 v2, s[8:11], s52 offen offset:1024 nt lds
    s_waitcnt vmcnt(9)
    s_add_u32 m0, s56, 64
    s_nop 0
    buffer_load_dwordx4 v2, s[8:11], s52 offen offset:2048 nt lds
    s_waitcnt vmcnt(9)
    s_add_u32 m0, s56, 96
    s_nop 0
    buffer_load_dwordx4 v2, s[8:11], s52 offen offset:3072 nt lds
    s_waitcnt vmcnt(9)
    s_add_u32 m0, s56, 4224
    s_xor_b32 s54, s40, 0x60000
    buffer_load_dwordx4 v2, s[8:11], s53 offen offset:0 nt lds
    s_waitcnt vmcnt(9)
    s_add_u32 m0, s56, 4256
    s_nop 0
    buffer_load_dwordx4 v2, s[8:11], s53 offen offset:1024 nt lds
    s_waitcnt vmcnt(9)
    s_add_u32 m0, s56, 4288
    s_nop 0
    buffer_load_dwordx4 v2, s[8:11], s53 offen offset:2048 nt lds
    s_waitcnt vmcnt(9)
    s_add_u32 m0, s56, 4320
    s_nop 0
    buffer_load_dwordx4 v2, s[8:11], s53 offen offset:3072 nt lds
    ds_read_b128 a[160:163], v4 offset:0
    ds_read_b128 a[164:167], v4 offset:64
    ds_read_b128 a[168:171], v4 offset:128
    ds_read_b128 a[172:175], v4 offset:192
    ds_read_b128 a[176:179], v4 offset:256
    ds_read_b128 a[180:183], v4 offset:320
    ds_read_b128 a[184:187], v4 offset:384
    ds_read_b128 a[188:191], v4 offset:448
    s_waitcnt lgkmcnt(0)
    s_waitcnt vmcnt(9)
    s_mov_b32 m0, s57
    s_xor_b32 s55, s40, 0xcb000
    buffer_load_dwordx4 v2, s[8:11], s54 offen offset:0 nt lds
    v_and_b32 v27, 3, v0
    v_lshlrev_b32 v27, 3, v27
    v_lshrrev_b32 v31, v27, s88
    v_bfe_u32 v28, v31, 0, 2
    v_bfe_u32 v29, v31, 2, 2
    v_bfe_u32 v30, v31, 4, 2
    v_bfe_u32 v31, v31, 6, 2
    v_and_b32 v96, 31, v0
    v_lshrrev_b32 v97, 5, v0
    v_lshlrev_b32 v97, 2, v97
    v_lshl_add_u32 v96, v96, 3, v97
    s_lshl_b32 s59, s3, 8
    s_add_u32 s59, s59, 150528
    v_add_u32 v96, s59, v96
    v_bfe_u32 v27, v0, 2, 1
    v_and_b32 v97, 48, v0
    v_lshl_add_u32 v97, v27, 9, v97
    v_add_u32 v97, 150528, v97
    s_waitcnt vmcnt(7)
    s_add_u32 m0, s57, 32
    s_nop 0
    buffer_load_dwordx4 v2, s[8:11], s54 offen offset:1024 nt lds
L_q_chk_1006:
    v_xor_b32 v84, v28, v84
    v_xor_b32 v85, v29, v85
    v_xor_b32 v86, v30, v86
    v_xor_b32 v87, v31, v87
    v_xor_b32 v88, v28, v88
    v_xor_b32 v89, v29, v89
    v_xor_b32 v90, v30, v90
    v_xor_b32 v91, v31, v91
    v_or3_b32 v94, v84, v85, v86
    v_or3_b32 v94, v94, v87, v88
    v_or3_b32 v94, v94, v89, v90
    v_or_b32 v94, v94, v91
    v_and_b32 v94, 3, v94
    v_cmp_ne_u32 vcc, 0, v94
    s_cbranch_vccz L_q_ok_1007
    buffer_load_dwordx4 v[84:87], v92, s[16:19], 0 offen sc1
    buffer_load_dwordx4 v[88:91], v93, s[16:19], 0 offen sc1
    s_add_u32 s92, s92, 1
    s_cmp_gt_u32 s92, 1048576
    s_cbranch_scc1 L_q_giveup_1008
    s_and_b32 s63, s92, 63
    s_cbranch_scc1 L_nowb_1009
    s_waitcnt vmcnt(0)
    buffer_wbl2 sc1
L_nowb_1009:
    s_waitcnt vmcnt(0)
    s_branch L_q_chk_1006
L_q_giveup_1008:
    s_waitcnt vmcnt(0)
L_q_ok_1007:
    v_add_f32 v84, v84, v88
    v_add_f32 v85, v85, v89
    v_add_f32 v86, v86, v90
    v_add_f32 v87, v87, v91
    s_nop 0
    v_permlane32_swap_b32 v84, v86
    v_permlane32_swap_b32 v85, v87
    v_add_f32 v84, v84, v86
    v_add_f32 v85, v85, v87
    v_cvt_pk_bf16_f32 v84, v84, v85
    ds_write_b32 v96, v84
    s_waitcnt vmcnt(7)
    s_add_u32 m0, s57, 64
    s_nop 0
    buffer_load_dwordx4 v2, s[8:11], s54 offen offset:2048 nt lds
    s_waitcnt lgkmcnt(0)
    s_barrier
    ds_read_b128 v[32:35], v97 offset:0
    ds_read_b128 v[36:39], v97 offset:64
    ds_read_b128 v[40:43], v97 offset:128
    ds_read_b128 v[44:47], v97 offset:192
    ds_read_b128 v[48:51], v97 offset:256
    ds_read_b128 v[52:55], v97 offset:320
    ds_read_b128 v[56:59], v97 offset:384
    ds_read_b128 v[60:63], v97 offset:448
    s_waitcnt vmcnt(7)
    s_add_u32 m0, s57, 96
    s_nop 0
    buffer_load_dwordx4 v2, s[8:11], s54 offen offset:3072 nt lds
    s_waitcnt lgkmcnt(0)
    v_mfma_f32_16x16x32_bf16 v[80:83], a[0:3], v[32:35], 0
    v_mfma_f32_16x16x32_bf16 v[80:83], a[4:7], v[36:39], v[80:83]
    v_mfma_f32_16x16x32_bf16 v[80:83], a[8:11], v[40:43], v[80:83]
    v_mfma_f32_16x16x32_bf16 v[80:83], a[12:15], v[44:47], v[80:83]
    v_mfma_f32_16x16x32_bf16 v[80:83], a[16:19], v[48:51], v[80:83]
    v_mfma_f32_16x16x32_bf16 v[80:83], a[20:23], v[52:55], v[80:83]
    v_mfma_f32_16x16x32_bf16 v[80:83], a[24:27], v[56:59], v[80:83]
    v_mfma_f32_16x16x32_bf16 v[80:83], a[28:31], v[60:63], v[80:83]
    s_mul_i32 s36, s3, 224
    s_movk_i32 s37, 0x60
    v_alignbit_b32 v26, v6, v6, 0
    s_add_u32 m0, s58, 0
    s_mov_b32 s60, 0
    v_bitop3_b32 v26, v1, v26, s37 bitop3:0x78
    buffer_load_dwordx4 v26, s[28:31], s60 offen  lds
    s_waitcnt vmcnt(8)
    s_add_u32 m0, s57, 4224
    s_nop 0
    buffer_load_dwordx4 v2, s[8:11], s55 offen offset:0 nt lds
    v_cndmask_b32 v64, v80, v81, s[98:99]
    v_cndmask_b32 v65, v82, v83, s[98:99]
    v_cvt_pk_bf16_f32 v64, 0, v64
    v_cvt_pk_bf16_f32 v65, 0, v65
    s_waitcnt lgkmcnt(0)
    v_mfma_f32_16x16x32_bf16 v[84:87], a[32:35], v[32:35], 0
    v_mfma_f32_16x16x32_bf16 v[84:87], a[36:39], v[36:39], v[84:87]
    v_mfma_f32_16x16x32_bf16 v[84:87], a[40:43], v[40:43], v[84:87]
    v_mfma_f32_16x16x32_bf16 v[84:87], a[44:47], v[44:47], v[84:87]
    v_mfma_f32_16x16x32_bf16 v[84:87], a[48:51], v[48:51], v[84:87]
    v_mfma_f32_16x16x32_bf16 v[84:87], a[52:55], v[52:55], v[84:87]
    v_mfma_f32_16x16x32_bf16 v[84:87], a[56:59], v[56:59], v[84:87]
    v_mfma_f32_16x16x32_bf16 v[84:87], a[60:63], v[60:63], v[84:87]
    v_alignbit_b32 v26, v6, v6, 2
    s_add_u32 m0, s58, 1024
    s_mov_b32 s60, 1024
    v_bitop3_b32 v26, v1, v26, s37 bitop3:0x78
    buffer_load_dwordx4 v26, s[28:31], s60 offen  lds
    s_waitcnt vmcnt(9)
    s_add_u32 m0, s57, 4256
    s_nop 0
    buffer_load_dwordx4 v2, s[8:11], s55 offen offset:1024 nt lds
    v_cndmask_b32 v66, v84, v85, s[98:99]
    v_cndmask_b32 v67, v86, v87, s[98:99]
    v_cvt_pk_bf16_f32 v66, 0, v66
    v_cvt_pk_bf16_f32 v67, 0, v67
    s_waitcnt lgkmcnt(0)
    v_mfma_f32_16x16x32_bf16 v[88:91], a[64:67], v[32:35], 0
    v_mfma_f32_16x16x32_bf16 v[88:91], a[68:71], v[36:39], v[88:91]
    v_mfma_f32_16x16x32_bf16 v[88:91], a[72:75], v[40:43], v[88:91]
    v_mfma_f32_16x16x32_bf16 v[88:91], a[76:79], v[44:47], v[88:91]
    v_mfma_f32_16x16x32_bf16 v[88:91], a[80:83], v[48:51], v[88:91]
    v_mfma_f32_16x16x32_bf16 v[88:91], a[84:87], v[52:55], v[88:91]
    v_mfma_f32_16x16x32_bf16 v[88:91], a[88:91], v[56:59], v[88:91]
    v_mfma_f32_16x16x32_bf16 v[88:91], a[92:95], v[60:63], v[88:91]
    s_waitcnt vmcnt(9)
    s_add_u32 m0, s57, 4288
    s_nop 0
    buffer_load_dwordx4 v2, s[8:11], s55 offen offset:2048 nt lds
    s_nop 3
    v_cndmask_b32 v68, v88, v89, s[98:99]
    v_cndmask_b32 v69, v90, v91, s[98:99]
    v_cvt_pk_bf16_f32 v68, 0, v68
    v_cvt_pk_bf16_f32 v69, 0, v69
    s_waitcnt lgkmcnt(0)
    v_mfma_f32_16x16x32_bf16 v[92:95], a[96:99], v[32:35], 0
    v_mfma_f32_16x16x32_bf16 v[92:95], a[100:103], v[36:39], v[92:95]
    v_mfma_f32_16x16x32_bf16 v[92:95], a[104:107], v[40:43], v[92:95]
    v_mfma_f32_16x16x32_bf16 v[92:95], a[108:111], v[44:47], v[92:95]
    v_mfma_f32_16x16x32_bf16 v[92:95], a[112:115], v[48:51], v[92:95]
    v_mfma_f32_16x16x32_bf16 v[92:95], a[116:119], v[52:55], v[92:95]
    v_mfma_f32_16x16x32_bf16 v[92:95], a[120:123], v[56:59], v[92:95]
    v_mfma_f32_16x16x32_bf16 v[92:95], a[124:127], v[60:63], v[92:95]
    v_alignbit_b32 v26, v6, v6, 4
    s_add_u32 m0, s58, 2048
    s_mov_b32 s60, 2048
    v_bitop3_b32 v26, v1, v26, s37 bitop3:0x78
    buffer_load_dwordx4 v26, s[28:31], s60 offen  lds
    s_waitcnt vmcnt(10)
    s_add_u32 m0, s57, 4320
    s_nop 0
    buffer_load_dwordx4 v2, s[8:11], s55 offen offset:3072 nt lds
    v_cndmask_b32 v70, v92, v93, s[98:99]
    v_cndmask_b32 v71, v94, v95, s[98:99]
    v_cvt_pk_bf16_f32 v70, 0, v70
    v_cvt_pk_bf16_f32 v71, 0, v71
    ds_read_b128 a[192:195], v3 offset:0
    ds_read_b128 a[196:199], v3 offset:64
    ds_read_b128 a[200:203], v3 offset:128
    ds_read_b128 a[204:207], v3 offset:192
    ds_read_b128 a[208:211], v3 offset:256
    ds_read_b128 a[212:215], v3 offset:320
    ds_read_b128 a[216:219], v3 offset:384
    ds_read_b128 a[220:223], v3 offset:448
    s_waitcnt lgkmcnt(0)
    s_waitcnt lgkmcnt(0)
    v_mfma_f32_16x16x32_bf16 v[80:83], a[128:131], v[32:35], 0
    v_mfma_f32_16x16x32_bf16 v[80:83], a[132:135], v[36:39], v[80:83]
    v_mfma_f32_16x16x32_bf16 v[80:83], a[136:139], v[40:43], v[80:83]
    v_mfma_f32_16x16x32_bf16 v[80:83], a[140:143], v[44:47], v[80:83]
    v_mfma_f32_16x16x32_bf16 v[80:83], a[144:147], v[48:51], v[80:83]
    v_mfma_f32_16x16x32_bf16 v[80:83], a[148:151], v[52:55], v[80:83]
    v_mfma_f32_16x16x32_bf16 v[80:83], a[152:155], v[56:59], v[80:83]
    v_mfma_f32_16x16x32_bf16 v[80:83], a[156:159], v[60:63], v[80:83]
    s_waitcnt vmcnt(10)
    v_lshrrev_b32 v5, 3, v0
    v_lshlrev_b32 v5, 9, v5
    v_and_b32 v26, 0x70, v1
    v_or_b32 v5, v5, v26
    s_lshl_b32 s59, s3, 3
    v_xor_b32 v26, s59, v0
    v_and_b32 v26, 8, v26
    v_lshl_add_u32 v5, v26, 13, v5
    s_add_u32 s59, s5, 1
    s_and_b32 s59, s59, 3
    s_lshl_b32 s59, s59, 7
    v_and_b32 v5, 0xfffffe7f, v5
    v_or_b32 v5, s59, v5
    buffer_load_dwordx4 a[0:3], v5, s[12:15], s40 offen nt
    v_cndmask_b32 v72, v80, v81, s[98:99]
    v_cndmask_b32 v73, v82, v83, s[98:99]
    v_cvt_pk_bf16_f32 v72, 0, v72
    v_cvt_pk_bf16_f32 v73, 0, v73
    s_waitcnt lgkmcnt(0)
    v_mfma_f32_16x16x32_bf16 v[84:87], a[160:163], v[32:35], 0
    v_mfma_f32_16x16x32_bf16 v[84:87], a[164:167], v[36:39], v[84:87]
    v_mfma_f32_16x16x32_bf16 v[84:87], a[168:171], v[40:43], v[84:87]
    v_mfma_f32_16x16x32_bf16 v[84:87], a[172:175], v[44:47], v[84:87]
    v_mfma_f32_16x16x32_bf16 v[84:87], a[176:179], v[48:51], v[84:87]
    v_mfma_f32_16x16x32_bf16 v[84:87], a[180:183], v[52:55], v[84:87]
    v_mfma_f32_16x16x32_bf16 v[84:87], a[184:187], v[56:59], v[84:87]
    v_mfma_f32_16x16x32_bf16 v[84:87], a[188:191], v[60:63], v[84:87]
    v_alignbit_b32 v26, v6, v6, 6
    s_add_u32 m0, s58, 3072
    s_mov_b32 s60, 3072
    v_bitop3_b32 v26, v1, v26, s37 bitop3:0x78
    buffer_load_dwordx4 v26, s[28:31], s60 offen  lds
    s_waitcnt vmcnt(11)
    buffer_load_dwordx4 a[4:7], v5, s[12:15], s41 offen nt
    s_nop 0
    v_cndmask_b32 v74, v84, v85, s[98:99]
    v_cndmask_b32 v75, v86, v87, s[98:99]
    v_cvt_pk_bf16_f32 v74, 0, v74
    v_cvt_pk_bf16_f32 v75, 0, v75
    s_waitcnt lgkmcnt(0)
    v_mfma_f32_16x16x32_bf16 v[88:91], a[192:195], v[32:35], 0
    v_mfma_f32_16x16x32_bf16 v[88:91], a[196:199], v[36:39], v[88:91]
    v_mfma_f32_16x16x32_bf16 v[88:91], a[200:203], v[40:43], v[88:91]
    v_mfma_f32_16x16x32_bf16 v[88:91], a[204:207], v[44:47], v[88:91]
    v_mfma_f32_16x16x32_bf16 v[88:91], a[208:211], v[48:51], v[88:91]
    v_mfma_f32_16x16x32_bf16 v[88:91], a[212:215], v[52:55], v[88:91]
    v_mfma_f32_16x16x32_bf16 v[88:91], a[216:219], v[56:59], v[88:91]
    v_mfma_f32_16x16x32_bf16 v[88:91], a[220:223], v[60:63], v[88:91]
    s_waitcnt vmcnt(11)
    buffer_load_dwordx4 a[8:11], v5, s[12:15], s42 offen nt
    s_nop 5
    v_cndmask_b32 v76, v88, v89, s[98:99]
    v_cndmask_b32 v77, v90, v91, s[98:99]
    v_cvt_pk_bf16_f32 v76, 0, v76
    v_cvt_pk_bf16_f32 v77, 0, v77
    s_lshl_b32 s59, s24, 7
    s_sub_u32 s20, s20, s59
    s_subb_u32 s21, s21, 0
    s_max_u32 s24, s93, 1
    s_sub_u32 s24, s24, 1
    s_lshl_b32 s59, s24, 7
    s_add_u32 s20, s20, s59
    s_addc_u32 s21, s21, 0
    s_mov_b32 s59, 688128
    s_bitcmp1_b32 s59, s93
    s_cselect_b32 s22, 596864, 0
    v_lshrrev_b32 v24, 2, v0
    v_and_b32 v25, 3, v0
    v_lshlrev_b32 v25, 3, v25
    v_lshl_add_u32 v24, v24, 7, v25
    v_add_u32 v8, s56, v24
    s_add_u32 m0, s56, 0
    s_mov_b32 s60, 0
    buffer_load_dwordx4 v7, s[20:23], s60 offen nt lds
    v_and_b32 v2, 24, v0
    v_lshlrev_b32 v2, 2, v2
    v_alignbit_b32 v26, v6, v6, 8
    s_add_u32 m0, s58, 4096
    s_mov_b32 s60, 4096
    v_bitop3_b32 v26, v1, v26, s37 bitop3:0x78
    buffer_load_dwordx4 v26, s[28:31], s60 offen  lds
    s_waitcnt vmcnt(13)
    buffer_load_dwordx4 a[12:15], v5, s[12:15], s43 offen nt
    s_waitcnt vmcnt(12)
    buffer_load_dwordx4 a[16:19], v5, s[12:15], s44 offen nt
    s_add_u32 m0, s56, 1024
    s_mov_b32 s60, 43008
    buffer_load_dwordx4 v7, s[20:23], s60 offen nt lds
    v_alignbit_b32 v26, v6, v6, 10
    s_add_u32 m0, s58, 5120
    s_mov_b32 s60, 5120
    v_bitop3_b32 v26, v1, v26, s37 bitop3:0x78
    buffer_load_dwordx4 v26, s[28:31], s60 offen  lds
    s_waitcnt vmcnt(13)
    buffer_load_dwordx4 a[20:23], v5, s[12:15], s45 offen nt
    s_waitcnt vmcnt(13)
    buffer_load_dwordx4 a[24:27], v5, s[12:15], s46 offen nt
    v_alignbit_b32 v26, v6, v6, 12
    s_add_u32 m0, s58, 6144
    s_mov_b32 s60, 6144
    v_bitop3_b32 v26, v1, v26, s37 bitop3:0x78
    buffer_load_dwordx4 v26, s[28:31], s60 offen  lds
    s_waitcnt vmcnt(13)
    buffer_load_dwordx4 a[28:31], v5, s[12:15], s47 offen nt
    ds_read_b128 a[224:227], v4 offset:0
    ds_read_b128 a[228:231], v4 offset:64
    ds_read_b128 a[232:235], v4 offset:128
    ds_read_b128 a[236:239], v4 offset:192
    ds_read_b128 a[240:243], v4 offset:256
    ds_read_b128 a[244:247], v4 offset:320
    ds_read_b128 a[248:251], v4 offset:384
    ds_read_b128 a[252:255], v4 offset:448
    s_add_u32 m0, s56, 2048
    s_mov_b32 s60, 86016
    buffer_load_dwordx4 v7, s[20:23], s60 offen nt lds
    s_waitcnt lgkmcnt(0)
    s_waitcnt vmcnt(14)
    buffer_load_dwordx4 a[32:35], v5, s[12:15], s48 offen nt
    s_waitcnt lgkmcnt(0)
    v_mfma_f32_16x16x32_bf16 v[92:95], a[224:227], v[32:35], 0
    v_mfma_f32_16x16x32_bf16 v[92:95], a[228:231], v[36:39], v[92:95]
    v_mfma_f32_16x16x32_bf16 v[92:95], a[232:235], v[40:43], v[92:95]
    v_mfma_f32_16x16x32_bf16 v[92:95], a[236:239], v[44:47], v[92:95]
    v_mfma_f32_16x16x32_bf16 v[92:95], a[240:243], v[48:51], v[92:95]
    v_mfma_f32_16x16x32_bf16 v[92:95], a[244:247], v[52:55], v[92:95]
    v_mfma_f32_16x16x32_bf16 v[92:95], a[248:251], v[56:59], v[92:95]
    v_mfma_f32_16x16x32_bf16 v[92:95], a[252:255], v[60:63], v[92:95]
    v_alignbit_b32 v26, v6, v6, 14
    s_add_u32 m0, s58, 7168
    s_mov_b32 s60, 7168
    v_bitop3_b32 v26, v1, v26, s37 bitop3:0x78
    buffer_load_dwordx4 v26, s[28:31], s60 offen  lds
    s_waitcnt vmcnt(14)
    buffer_load_dwordx4 a[36:39], v5, s[12:15], s49 offen nt
    s_nop 0
    v_cndmask_b32 v78, v92, v93, s[98:99]
    v_cndmask_b32 v79, v94, v95, s[98:99]
    v_cvt_pk_bf16_f32 v78, 0, v78
    v_cvt_pk_bf16_f32 v79, 0, v79
    s_add_u32 m0, s56, 3072
    s_mov_b32 s60, 129024
    buffer_load_dwordx4 v7, s[20:23], s60 offen nt lds
    v_max3_f32 v28, v64, v65, v66
    v_max3_f32 v28, v28, v67, v68
    v_max3_f32 v28, v28, v69, v70
    v_max3_f32 v28, v28, v71, v72
    v_max3_f32 v28, v28, v73, v74
    v_max3_f32 v28, v28, v75, v76
    v_max3_f32 v28, v28, v77, v78
    v_max_f32 v28, v28, v79
    s_nop 1
    v_max_f32_dpp v28, v28, v28 row_ror:8 row_mask:0xf bank_mask:0xf
    v_mov_b32 v24, v28
    s_nop 1
    v_permlane16_swap_b32 v28, v24
    v_max_f32 v28, v28, v24
    v_mov_b32 v24, v28
    s_nop 1
    v_permlane32_swap_b32 v28, v24
    v_max_f32 v28, v28, v24
    s_waitcnt vmcnt(15)
    buffer_load_dwordx4 a[40:43], v5, s[12:15], s50 offen nt
    s_mov_b32 s59, 1035512379
    v_sub_f32 v64, v64, v28
    v_sub_f32 v65, v65, v28
    v_sub_f32 v66, v66, v28
    v_sub_f32 v67, v67, v28
    v_sub_f32 v68, v68, v28
    v_sub_f32 v69, v69, v28
    v_sub_f32 v70, v70, v28
    v_sub_f32 v71, v71, v28
    v_sub_f32 v72, v72, v28
    v_sub_f32 v73, v73, v28
    v_sub_f32 v74, v74, v28
    v_sub_f32 v75, v75, v28
    v_sub_f32 v76, v76, v28
    v_sub_f32 v77, v77, v28
    v_sub_f32 v78, v78, v28
    v_sub_f32 v79, v79, v28
    v_mul_f32 v64, s59, v64
    v_mul_f32 v65, s59, v65
    v_mul_f32 v66, s59, v66
    v_mul_f32 v67, s59, v67
    v_mul_f32 v68, s59, v68
    v_mul_f32 v69, s59, v69
    v_mul_f32 v70, s59, v70
    v_mul_f32 v71, s59, v71
    v_mul_f32 v72, s59, v72
    v_mul_f32 v73, s59, v73
    v_mul_f32 v74, s59, v74
    v_mul_f32 v75, s59, v75
    v_mul_f32 v76, s59, v76
    v_mul_f32 v77, s59, v77
    v_mul_f32 v78, s59, v78
    v_mul_f32 v79, s59, v79
    v_alignbit_b32 v26, v6, v6, 16
    s_add_u32 m0, s58, 8192
    s_mov_b32 s60, 8192
    v_bitop3_b32 v26, v1, v26, s37 bitop3:0x78
    buffer_load_dwordx4 v26, s[28:31], s60 offen  lds
    s_waitcnt vmcnt(14)
    buffer_load_dwordx4 a[44:47], v5, s[12:15], s51 offen nt
    v_exp_f32 v64, v64
    v_exp_f32 v65, v65
    v_exp_f32 v66, v66
    v_exp_f32 v67, v67
    v_exp_f32 v68, v68
    v_exp_f32 v69, v69
    v_exp_f32 v70, v70
    v_exp_f32 v71, v71
    v_exp_f32 v72, v72
    v_exp_f32 v73, v73
    v_exp_f32 v74, v74
    v_exp_f32 v75, v75
    v_exp_f32 v76, v76
    v_exp_f32 v77, v77
    v_exp_f32 v78, v78
    v_exp_f32 v79, v79
    v_add_f32 v29, v64, v65
    v_add_f32 v29, v29, v66
    v_add_f32 v29, v29, v67
    v_add_f32 v29, v29, v68
    v_add_f32 v29, v29, v69
    v_add_f32 v29, v29, v70
    v_add_f32 v29, v29, v71
    v_add_f32 v29, v29, v72
    v_add_f32 v29, v29, v73
    v_add_f32 v29, v29, v74
    v_add_f32 v29, v29, v75
    v_add_f32 v29, v29, v76
    v_add_f32 v29, v29, v77
    v_add_f32 v29, v29, v78
    v_add_f32 v29, v29, v79
    s_waitcnt vmcnt(14)
    buffer_load_dwordx4 a[48:51], v5, s[12:15], s52 offen nt
    s_add_u32 m0, s56, 4096
    s_mov_b32 s60, 172032
    buffer_load_dwordx4 v7, s[20:23], s60 offen nt lds
    v_add_f32_dpp v29, v29, v29 row_ror:8 row_mask:0xf bank_mask:0xf
    v_mov_b32 v24, v29
    s_nop 1
    v_permlane16_swap_b32 v29, v24
    v_add_f32 v29, v29, v24
    v_mov_b32 v24, v29
    s_nop 1
    v_permlane32_swap_b32 v29, v24
    v_add_f32 v29, v29, v24
    s_lshl3_add_u32 s59, s6, s4
    s_lshl_b32 s59, s59, 9
    s_add_u32 s59, s59, 917504
    v_and_b32 v30, 31, v0
    v_lshl_add_u32 v30, v30, 4, s59
    s_lshl2_add_u32 s60, s5, s3
    s_lshl4_add_u32 s59, s60, s59
    v_lshl_add_u32 v24, v0, 6, s59
    v_and_b32 v25, 59, v0
    v_cmp_eq_u32 vcc, 0, v25
    v_mov_b32 v25, 1073741824
    s_nop 0
    v_cndmask_b32 v24, v25, v24, vcc
    v_or_b32 v92, s89, v28
    v_mov_b32 v93, v29
    v_mov_b32 v94, s88
    buffer_store_dwordx3 v[92:94], v24, s[16:19], 0 offen
    v_alignbit_b32 v26, v6, v6, 18
    s_add_u32 m0, s58, 9216
    s_mov_b32 s60, 9216
    v_bitop3_b32 v26, v1, v26, s37 bitop3:0x78
    buffer_load_dwordx4 v26, s[28:31], s60 offen  lds
    s_waitcnt vmcnt(15)
    buffer_load_dwordx4 a[52:55], v5, s[12:15], s53 offen nt
    ds_read_b64_tr_b16 v[144:145], v8 offset:0
    ds_read_b64_tr_b16 v[146:147], v8 offset:32
    ds_read_b64_tr_b16 v[148:149], v8 offset:64
    ds_read_b64_tr_b16 v[150:151], v8 offset:96
    v_cvt_pk_bf16_f32 v64, v64, v64
    v_cvt_pk_bf16_f32 v65, v65, v65
    v_cvt_pk_bf16_f32 v66, v66, v66
    v_cvt_pk_bf16_f32 v67, v67, v67
    v_cvt_pk_bf16_f32 v68, v68, v68
    v_cvt_pk_bf16_f32 v69, v69, v69
    v_cvt_pk_bf16_f32 v70, v70, v70
    v_cvt_pk_bf16_f32 v71, v71, v71
    v_and_b32 v32, v64, v10
    v_and_b32 v33, v64, v11
    v_and_b32 v34, v65, v10
    v_and_b32 v35, v65, v11
    v_and_b32 v36, v66, v10
    v_and_b32 v37, v66, v11
    v_and_b32 v38, v67, v10
    v_and_b32 v39, v67, v11
    v_and_b32 v40, v68, v10
    v_and_b32 v41, v68, v11
    v_and_b32 v42, v69, v10
    v_and_b32 v43, v69, v11
    v_and_b32 v44, v70, v10
    v_and_b32 v45, v70, v11
    v_and_b32 v46, v71, v10
    v_and_b32 v47, v71, v11
    v_alignbit_b32 v26, v6, v6, 20
    s_add_u32 m0, s58, 10240
    s_mov_b32 s60, 10240
    v_bitop3_b32 v26, v1, v26, s37 bitop3:0x78
    buffer_load_dwordx4 v26, s[28:31], s60 offen  lds
    s_waitcnt vmcnt(16)
    buffer_load_dwordx4 a[56:59], v5, s[12:15], s54 offen nt
    s_add_u32 m0, s56, 5120
    s_mov_b32 s60, 215040
    buffer_load_dwordx4 v7, s[20:23], s60 offen nt lds
    v_cvt_pk_bf16_f32 v72, v72, v72
    v_cvt_pk_bf16_f32 v73, v73, v73
    v_cvt_pk_bf16_f32 v74, v74, v74
    v_cvt_pk_bf16_f32 v75, v75, v75
    v_cvt_pk_bf16_f32 v76, v76, v76
    v_cvt_pk_bf16_f32 v77, v77, v77
    v_cvt_pk_bf16_f32 v78, v78, v78
    v_cvt_pk_bf16_f32 v79, v79, v79
    v_and_b32 v48, v72, v10
    v_and_b32 v49, v72, v11
    v_and_b32 v50, v73, v10
    v_and_b32 v51, v73, v11
    v_and_b32 v52, v74, v10
    v_and_b32 v53, v74, v11
    v_and_b32 v54, v75, v10
    v_and_b32 v55, v75, v11
    v_and_b32 v56, v76, v10
    v_and_b32 v57, v76, v11
    v_and_b32 v58, v77, v10
    v_and_b32 v59, v77, v11
    v_and_b32 v60, v78, v10
    v_and_b32 v61, v78, v11
    v_and_b32 v62, v79, v10
    v_and_b32 v63, v79, v11
    s_waitcnt vmcnt(16)
    buffer_load_dwordx4 a[60:63], v5, s[12:15], s55 offen nt
    v_mfma_f32_16x16x16_bf16 v[96:99], v[32:33], a[0:1], 0
    v_mfma_f32_16x16x16_bf16 v[100:103], v[32:33], a[2:3], 0
    v_mfma_f32_16x16x16_bf16 v[96:99], v[34:35], a[4:5], v[96:99]
    v_mfma_f32_16x16x16_bf16 v[100:103], v[34:35], a[6:7], v[100:103]
    v_mfma_f32_16x16x16_bf16 v[96:99], v[36:37], a[8:9], v[96:99]
    v_mfma_f32_16x16x16_bf16 v[100:103], v[36:37], a[10:11], v[100:103]
    v_alignbit_b32 v26, v6, v6, 22
    s_add_u32 m0, s58, 11264
    s_mov_b32 s60, 11264
    v_bitop3_b32 v26, v1, v26, s37 bitop3:0x78
    buffer_load_dwordx4 v26, s[28:31], s60 offen  lds
    s_waitcnt vmcnt(16)
    s_add_u32 s59, s5, 2
    s_and_b32 s59, s59, 3
    s_lshl_b32 s59, s59, 7
    v_and_b32 v5, 0xfffffe7f, v5
    v_or_b32 v5, s59, v5
    buffer_load_dwordx4 a[64:67], v5, s[12:15], s40 offen nt
    v_mfma_f32_16x16x16_bf16 v[96:99], v[38:39], a[12:13], v[96:99]
    v_mfma_f32_16x16x16_bf16 v[100:103], v[38:39], a[14:15], v[100:103]
    v_mfma_f32_16x16x16_bf16 v[96:99], v[40:41], a[16:17], v[96:99]
    v_mfma_f32_16x16x16_bf16 v[100:103], v[40:41], a[18:19], v[100:103]
    v_mfma_f32_16x16x16_bf16 v[96:99], v[42:43], a[20:21], v[96:99]
    v_mfma_f32_16x16x16_bf16 v[100:103], v[42:43], a[22:23], v[100:103]
    s_waitcnt vmcnt(15)
    buffer_load_dwordx4 a[68:71], v5, s[12:15], s41 offen nt
    s_add_u32 m0, s56, 6144
    s_mov_b32 s60, 258048
    buffer_load_dwordx4 v7, s[20:23], s60 offen nt lds
    v_mfma_f32_16x16x16_bf16 v[96:99], v[44:45], a[24:25], v[96:99]
    v_mfma_f32_16x16x16_bf16 v[100:103], v[44:45], a[26:27], v[100:103]
    v_mfma_f32_16x16x16_bf16 v[96:99], v[46:47], a[28:29], v[96:99]
    v_mfma_f32_16x16x16_bf16 v[100:103], v[46:47], a[30:31], v[100:103]
    v_mfma_f32_16x16x16_bf16 v[96:99], v[48:49], a[32:33], v[96:99]
    v_mfma_f32_16x16x16_bf16 v[100:103], v[48:49], a[34:35], v[100:103]
    v_alignbit_b32 v26, v6, v6, 24
    s_add_u32 m0, s58, 12288
    s_mov_b32 s60, 12288
    v_bitop3_b32 v26, v1, v26, s37 bitop3:0x78
    buffer_load_dwordx4 v26, s[28:31], s60 offen  lds
    s_waitcnt vmcnt(16)
    buffer_load_dwordx4 a[72:75], v5, s[12:15], s42 offen nt
    s_waitcnt lgkmcnt(0)
    v_mfma_f32_16x16x16_bf16 v[160:163], v[144:145], v[128:129], 0
    v_mfma_f32_16x16x16_bf16 v[164:167], v[146:147], v[128:129], 0
    v_mfma_f32_16x16x16_bf16 v[168:171], v[148:149], v[128:129], 0
    v_mfma_f32_16x16x16_bf16 v[172:175], v[150:151], v[128:129], 0
    ds_read_b64_tr_b16 v[152:153], v8 offset:2048
    ds_read_b64_tr_b16 v[154:155], v8 offset:2080
    ds_read_b64_tr_b16 v[156:157], v8 offset:2112
    ds_read_b64_tr_b16 v[158:159], v8 offset:2144
    v_mfma_f32_16x16x16_bf16 v[96:99], v[50:51], a[36:37], v[96:99]
    v_mfma_f32_16x16x16_bf16 v[100:103], v[50:51], a[38:39], v[100:103]
    v_mfma_f32_16x16x16_bf16 v[96:99], v[52:53], a[40:41], v[96:99]
    v_mfma_f32_16x16x16_bf16 v[100:103], v[52:53], a[42:43], v[100:103]
    s_waitcnt vmcnt(15)
    buffer_load_dwordx4 a[76:79], v5, s[12:15], s43 offen nt
    v_mfma_f32_16x16x16_bf16 v[96:99], v[54:55], a[44:45], v[96:99]
    v_mfma_f32_16x16x16_bf16 v[100:103], v[54:55], a[46:47], v[100:103]
    v_alignbit_b32 v26, v6, v6, 26
    s_add_u32 m0, s58, 13312
    s_mov_b32 s60, 13312
    v_bitop3_b32 v26, v1, v26, s37 bitop3:0x78
    buffer_load_dwordx4 v26, s[28:31], s60 offen  lds
    s_waitcnt vmcnt(16)
    buffer_load_dwordx4 a[80:83], v5, s[12:15], s44 offen nt
    s_add_u32 m0, s56, 7168
    s_mov_b32 s60, 301056
    buffer_load_dwordx4 v7, s[20:23], s60 offen nt lds
    v_mfma_f32_16x16x16_bf16 v[96:99], v[56:57], a[48:49], v[96:99]
    v_mfma_f32_16x16x16_bf16 v[100:103], v[56:57], a[50:51], v[100:103]
    s_waitcnt vmcnt(14)
    buffer_load_dwordx4 a[84:87], v5, s[12:15], s45 offen nt
    v_mfma_f32_16x16x16_bf16 v[96:99], v[58:59], a[52:53], v[96:99]
    v_mfma_f32_16x16x16_bf16 v[100:103], v[58:59], a[54:55], v[100:103]
    v_alignbit_b32 v26, v6, v6, 0
    s_add_u32 m0, s57, 0
    s_mov_b32 s60, 229376
    v_bitop3_b32 v26, v1, v26, s37 bitop3:0x78
    buffer_load_dwordx4 v26, s[28:31], s60 offen  lds
    s_waitcnt vmcnt(14)
    buffer_load_dwordx4 a[88:91], v5, s[12:15], s46 offen nt
    s_add_u32 m0, s56, 0
    s_mov_b32 s60, 344064
    buffer_load_dwordx4 v7, s[20:23], s60 offen nt lds
    v_mfma_f32_16x16x16_bf16 v[96:99], v[60:61], a[56:57], v[96:99]
    v_mfma_f32_16x16x16_bf16 v[100:103], v[60:61], a[58:59], v[100:103]
    v_and_b32 v24, 1, v0
    v_mul_u32_u24 v10, 0xaaaa, v24
    v_bfe_u32 v25, v0, 2, 1
    v_mul_u32_u24 v25, 0xaaaa, v25
    v_lshl_or_b32 v10, v25, 16, v10
    v_add_u32 v10, 0x44444444, v10
    v_lshlrev_b32 v24, 4, v24
    v_bfe_u32 v29, s88, v24, 16
    v_and_b32 v11, 0xbfff, v29
    v_mov_b32 v25, 0x3f80
    v_lshlrev_b32 v25, v24, v25
    v_and_b32 v24, 13, v0
    v_cmp_eq_u32 vcc, 0, v24
    s_nop 1
    v_cndmask_b32 v25, v25, 0, vcc
    v_cndmask_b32 v124, 0, v25, s[94:95]
    v_cndmask_b32 v125, 0, v25, s[98:99]
    v_cndmask_b32 v126, 0, v25, s[94:95]
    v_cndmask_b32 v127, 0, v25, s[98:99]
    s_waitcnt vmcnt(14)
    buffer_load_dwordx4 a[92:95], v5, s[12:15], s47 offen nt
    s_waitcnt lgkmcnt(0)
    v_mfma_f32_16x16x16_bf16 v[160:163], v[152:153], v[130:131], v[160:163]
    v_mfma_f32_16x16x16_bf16 v[164:167], v[154:155], v[130:131], v[164:167]
    v_mfma_f32_16x16x16_bf16 v[168:171], v[156:157], v[130:131], v[168:171]
    v_mfma_f32_16x16x16_bf16 v[172:175], v[158:159], v[130:131], v[172:175]
    ds_read_b64_tr_b16 v[144:145], v8 offset:4096
    ds_read_b64_tr_b16 v[146:147], v8 offset:4128
    ds_read_b64_tr_b16 v[148:149], v8 offset:4160
    ds_read_b64_tr_b16 v[150:151], v8 offset:4192
    v_mfma_f32_16x16x16_bf16 v[96:99], v[62:63], a[60:61], v[96:99]
    v_mfma_f32_16x16x16_bf16 v[100:103], v[62:63], a[62:63], v[100:103]
    v_alignbit_b32 v26, v6, v6, 2
    s_add_u32 m0, s57, 1024
    s_mov_b32 s60, 230400
    v_bitop3_b32 v26, v1, v26, s37 bitop3:0x78
    buffer_load_dwordx4 v26, s[28:31], s60 offen  lds
    s_lshl_b32 s60, s93, 13
    s_lshl_b32 s61, s3, 6
    s_add_u32 s60, s60, s61
    v_lshrrev_b32 v24, 2, v0
    v_and_b32 v25, 3, v0
    v_lshlrev_b32 v26, 4, v25
    v_lshl_add_u32 v24, v24, 8, v26
    v_add_u32 v14, s60, v24
    v_mov_b32 v24, 1073741824
    v_cmp_gt_u32 vcc, 48, v0
    s_nop 1
    v_cndmask_b32 v22, v24, v14, vcc
    v_cndmask_b32 v23, 0, v11, vcc
    v_lshrrev_b32 v24, 3, v0
    v_max_u32 v24, 1, v24
    v_lshl_add_u32 v24, v24, 4, v25
    s_mul_i32 s59, s93, 112
    s_lshl2_add_u32 s59, s3, s59
    s_sub_u32 s59, s59, 16
    v_add_lshl_u32 v3, v24, s59, 1
    s_mul_i32 s59, s6, 5376
    s_add_u32 s59, s59, 983040
    v_lshl_add_u32 v4, v3, 1, s59
    v_add_u32 v19, 5376, v4
    s_mov_b32 s100, 0xf0f0f000
    s_mov_b32 s101, 0xf0f0f0f0
    global_load_short_d16_hi v18, v3, s[64:65]
    s_waitcnt vmcnt(15)
    buffer_load_dwordx4 a[96:99], v5, s[12:15], s48 offen nt
    v_mfma_f32_16x16x16_bf16 v[104:107], v[32:33], a[64:65], 0
    v_mfma_f32_16x16x16_bf16 v[108:111], v[32:33], a[66:67], 0
    s_waitcnt vmcnt(15)
    buffer_load_dwordx4 a[100:103], v5, s[12:15], s49 offen nt
    s_add_u32 m0, s56, 1024
    s_mov_b32 s60, 387072
    buffer_load_dwordx4 v7, s[20:23], s60 offen nt lds
    v_mfma_f32_16x16x16_bf16 v[104:107], v[34:35], a[68:69], v[104:107]
    v_mfma_f32_16x16x16_bf16 v[108:111], v[34:35], a[70:71], v[108:111]
    v_alignbit_b32 v26, v6, v6, 4
    s_add_u32 m0, s57, 2048
    s_mov_b32 s60, 231424
    v_bitop3_b32 v26, v1, v26, s37 bitop3:0x78
    buffer_load_dwordx4 v26, s[28:31], s60 offen  lds
    s_waitcnt vmcnt(15)
    buffer_load_dwordx4 a[104:107], v5, s[12:15], s50 offen nt
    v_mfma_f32_16x16x16_bf16 v[104:107], v[36:37], a[72:73], v[104:107]
    v_mfma_f32_16x16x16_bf16 v[108:111], v[36:37], a[74:75], v[108:111]
    s_waitcnt vmcnt(15)
    buffer_load_dwordx4 a[108:111], v5, s[12:15], s51 offen nt
    s_add_u32 m0, s56, 2048
    s_mov_b32 s60, 430080
    buffer_load_dwordx4 v7, s[20:23], s60 offen nt lds
    v_mfma_f32_16x16x16_bf16 v[104:107], v[38:39], a[76:77], v[104:107]
    v_mfma_f32_16x16x16_bf16 v[108:111], v[38:39], a[78:79], v[108:111]
    v_alignbit_b32 v26, v6, v6, 6
    s_add_u32 m0, s57, 3072
    s_mov_b32 s60, 232448
    v_bitop3_b32 v26, v1, v26, s37 bitop3:0x78
    buffer_load_dwordx4 v26, s[28:31], s60 offen  lds
    buffer_load_dwordx3 v[80:82], v30, s[16:19], 0 offen sc1
    s_waitcnt vmcnt(17)
    buffer_load_dwordx4 a[112:115], v5, s[12:15], s52 offen nt
    v_mfma_f32_16x16x16_bf16 v[104:107], v[40:41], a[80:81], v[104:107]
    v_mfma_f32_16x16x16_bf16 v[108:111], v[40:41], a[82:83], v[108:111]
    s_waitcnt lgkmcnt(0)
    s_barrier
    s_waitcnt vmcnt(16)
    buffer_load_dwordx4 a[116:119], v5, s[12:15], s53 offen nt
    s_waitcnt lgkmcnt(0)
    v_mfma_f32_16x16x16_bf16 v[160:163], v[144:145], v[132:133], v[160:163]
    v_mfma_f32_16x16x16_bf16 v[164:167], v[146:147], v[132:133], v[164:167]
    v_mfma_f32_16x16x16_bf16 v[168:171], v[148:149], v[132:133], v[168:171]
    v_mfma_f32_16x16x16_bf16 v[172:175], v[150:151], v[132:133], v[172:175]
    ds_read_b64_tr_b16 v[152:153], v8 offset:6144
    ds_read_b64_tr_b16 v[154:155], v8 offset:6176
    ds_read_b64_tr_b16 v[156:157], v8 offset:6208
    ds_read_b64_tr_b16 v[158:159], v8 offset:6240
    v_mfma_f32_16x16x16_bf16 v[104:107], v[42:43], a[84:85], v[104:107]
    v_mfma_f32_16x16x16_bf16 v[108:111], v[42:43], a[86:87], v[108:111]
    v_alignbit_b32 v26, v6, v6, 8
    s_add_u32 m0, s57, 4096
    s_mov_b32 s60, 233472
    v_bitop3_b32 v26, v1, v26, s37 bitop3:0x78
    buffer_load_dwordx4 v26, s[28:31], s60 offen  lds
    s_add_u32 s59, s36, 57344
    v_xad_u32 v27, v2, s59, v9
    ds_read_b64_tr_b16 a[128:129], v27 offset:0
    ds_read_b64_tr_b16 a[130:131], v27 offset:3584
    ds_read_b64_tr_b16 a[132:133], v27 offset:28672
    ds_read_b64_tr_b16 a[134:135], v27 offset:32256
    s_add_u32 s59, s36, 57376
    v_xad_u32 v27, v2, s59, v9
    ds_read_b64_tr_b16 a[144:145], v27 offset:0
    ds_read_b64_tr_b16 a[146:147], v27 offset:3584
    ds_read_b64_tr_b16 a[148:149], v27 offset:28672
    ds_read_b64_tr_b16 a[150:151], v27 offset:32256
    s_add_u32 s59, s36, 57408
    v_xad_u32 v27, v2, s59, v9
    ds_read_b64_tr_b16 a[160:161], v27 offset:0
    ds_read_b64_tr_b16 a[162:163], v27 offset:3584
    ds_read_b64_tr_b16 a[164:165], v27 offset:28672
    ds_read_b64_tr_b16 a[166:167], v27 offset:32256
    s_add_u32 s59, s36, 57440
    v_xad_u32 v27, v2, s59, v9
    ds_read_b64_tr_b16 a[176:177], v27 offset:0
    ds_read_b64_tr_b16 a[178:179], v27 offset:3584
    ds_read_b64_tr_b16 a[180:181], v27 offset:28672
    ds_read_b64_tr_b16 a[182:183], v27 offset:32256
    s_waitcnt vmcnt(16)
    buffer_load_dwordx4 a[120:123], v5, s[12:15], s54 offen nt
    s_add_u32 m0, s56, 3072
    s_mov_b32 s60, 473088
    buffer_load_dwordx4 v7, s[20:23], s60 offen nt lds
    v_mfma_f32_16x16x16_bf16 v[104:107], v[44:45], a[88:89], v[104:107]
    v_mfma_f32_16x16x16_bf16 v[108:111], v[44:45], a[90:91], v[108:111]
    v_alignbit_b32 v26, v6, v6, 10
    s_add_u32 m0, s57, 5120
    s_mov_b32 s60, 234496
    v_bitop3_b32 v26, v1, v26, s37 bitop3:0x78
    buffer_load_dwordx4 v26, s[28:31], s60 offen  lds
    s_add_u32 s59, s36, 57472
    v_xad_u32 v27, v2, s59, v9
    ds_read_b64_tr_b16 a[192:193], v27 offset:0
    ds_read_b64_tr_b16 a[194:195], v27 offset:3584
    ds_read_b64_tr_b16 a[196:197], v27 offset:28672
    ds_read_b64_tr_b16 a[198:199], v27 offset:32256
    s_add_u32 s59, s36, 57504
    v_xad_u32 v27, v2, s59, v9
    ds_read_b64_tr_b16 a[208:209], v27 offset:0
    ds_read_b64_tr_b16 a[210:211], v27 offset:3584
    ds_read_b64_tr_b16 a[212:213], v27 offset:28672
    ds_read_b64_tr_b16 a[214:215], v27 offset:32256
    s_add_u32 s59, s36, 57536
    v_xad_u32 v27, v2, s59, v9
    ds_read_b64_tr_b16 a[224:225], v27 offset:0
    ds_read_b64_tr_b16 a[226:227], v27 offset:3584
    ds_read_b64_tr_b16 a[228:229], v27 offset:28672
    ds_read_b64_tr_b16 a[230:231], v27 offset:32256
    s_waitcnt vmcnt(17)
    buffer_load_dwordx4 a[124:127], v5, s[12:15], s55 offen nt
    v_mfma_f32_16x16x16_bf16 v[104:107], v[46:47], a[92:93], v[104:107]
    v_mfma_f32_16x16x16_bf16 v[108:111], v[46:47], a[94:95], v[108:111]
    s_waitcnt vmcnt(15)
    s_add_u32 s59, s5, 3
    s_and_b32 s59, s59, 3
    s_lshl_b32 s59, s59, 7
    v_and_b32 v5, 0xfffffe7f, v5
    v_or_b32 v5, s59, v5
    buffer_load_dwordx4 a[0:3], v5, s[12:15], s40 offen nt
    s_add_u32 m0, s56, 4096
    s_mov_b32 s60, 516096
    buffer_load_dwordx4 v7, s[20:23], s60 offen nt lds
    v_mfma_f32_16x16x16_bf16 v[104:107], v[48:49], a[96:97], v[104:107]
    v_mfma_f32_16x16x16_bf16 v[108:111], v[48:49], a[98:99], v[108:111]
    v_alignbit_b32 v26, v6, v6, 12
    s_add_u32 m0, s57, 6144
    s_mov_b32 s60, 235520
    v_bitop3_b32 v26, v1, v26, s37 bitop3:0x78
    buffer_load_dwordx4 v26, s[28:31], s60 offen  lds
    s_waitcnt vmcnt(17)
    buffer_load_dwordx4 a[4:7], v5, s[12:15], s41 offen nt
    v_mfma_f32_16x16x16_bf16 v[104:107], v[50:51], a[100:101], v[104:107]
    v_mfma_f32_16x16x16_bf16 v[108:111], v[50:51], a[102:103], v[108:111]
    s_waitcnt vmcnt(15)
    buffer_load_dwordx4 a[8:11], v5, s[12:15], s42 offen nt
    s_waitcnt lgkmcnt(0)
    v_mfma_f32_16x16x16_bf16 v[160:163], v[152:153], v[134:135], v[160:163]
    v_mfma_f32_16x16x16_bf16 v[164:167], v[154:155], v[134:135], v[164:167]
    v_mfma_f32_16x16x16_bf16 v[168:171], v[156:157], v[134:135], v[168:171]
    v_mfma_f32_16x16x16_bf16 v[172:175], v[158:159], v[134:135], v[172:175]
    ds_read_b64_tr_b16 v[144:145], v8 offset:0
    ds_read_b64_tr_b16 v[146:147], v8 offset:32
    ds_read_b64_tr_b16 v[148:149], v8 offset:64
    ds_read_b64_tr_b16 v[150:151], v8 offset:96
    v_mfma_f32_16x16x16_bf16 v[104:107], v[52:53], a[104:105], v[104:107]
    v_mfma_f32_16x16x16_bf16 v[108:111], v[52:53], a[106:107], v[108:111]
    v_alignbit_b32 v26, v6, v6, 14
    s_add_u32 m0, s57, 7168
    s_mov_b32 s60, 236544
    v_bitop3_b32 v26, v1, v26, s37 bitop3:0x78
    buffer_load_dwordx4 v26, s[28:31], s60 offen  lds
    s_waitcnt vmcnt(16)
    buffer_load_dwordx4 a[12:15], v5, s[12:15], s43 offen nt
    s_add_u32 m0, s56, 5120
    s_mov_b32 s60, 559104
    buffer_load_dwordx4 v7, s[20:23], s60 offen nt lds
    v_mfma_f32_16x16x16_bf16 v[104:107], v[54:55], a[108:109], v[104:107]
    v_mfma_f32_16x16x16_bf16 v[108:111], v[54:55], a[110:111], v[108:111]
    s_waitcnt vmcnt(14)
    buffer_load_dwordx4 a[16:19], v5, s[12:15], s44 offen nt
    v_mfma_f32_16x16x16_bf16 v[104:107], v[56:57], a[112:113], v[104:107]
    v_mfma_f32_16x16x16_bf16 v[108:111], v[56:57], a[114:115], v[108:111]
    v_alignbit_b32 v26, v6, v6, 16
    s_add_u32 m0, s57, 8192
    s_mov_b32 s60, 237568
    v_bitop3_b32 v26, v1, v26, s37 bitop3:0x78
    buffer_load_dwordx4 v26, s[28:31], s60 offen  lds
L_ml_chk_1010:
    v_xor_b32 v80, s89, v80
    v_xor_b32 v82, s88, v82
    v_lshl_or_b32 v82, v80, 16, v82
    v_cmp_ne_u32 vcc, 0, v82
    s_cbranch_vccz L_ml_ok_1011
    buffer_load_dwordx3 v[80:82], v30, s[16:19], 0 offen sc1
    s_add_u32 s92, s92, 1
    s_cmp_gt_u32 s92, 1048576
    s_cbranch_scc1 L_ml_giveup_1012
    s_and_b32 s63, s92, 63
    s_cbranch_scc1 L_nowb_1013
    s_waitcnt vmcnt(0)
    buffer_wbl2 sc1
L_nowb_1013:
    s_waitcnt vmcnt(0)
    s_branch L_ml_chk_1010
L_ml_giveup_1012:
    s_waitcnt vmcnt(0)
L_ml_ok_1011:
    v_max_f32_dpp v82, v80, v80 row_ror:8 row_mask:0xf bank_mask:0xf
    s_nop 1
    v_max_f32_dpp v82, v82, v82 row_ror:4 row_mask:0xf bank_mask:0xf
    s_nop 1
    v_max_f32_dpp v82, v82, v82 row_ror:2 row_mask:0xf bank_mask:0xf
    s_nop 1
    v_max_f32_dpp v82, v82, v82 row_ror:1 row_mask:0xf bank_mask:0xf
    s_mov_b32 s59, 1035512379
    v_sub_f32 v83, v80, v82
    v_mul_f32 v83, s59, v83
    v_exp_f32 v83, v83
    s_nop 0
    v_mul_f32 v83, v83, v81
    s_nop 1
    v_add_f32_dpp v83, v83, v83 row_ror:8 row_mask:0xf bank_mask:0xf
    s_nop 1
    v_add_f32_dpp v83, v83, v83 row_ror:4 row_mask:0xf bank_mask:0xf
    s_nop 1
    v_add_f32_dpp v83, v83, v83 row_ror:2 row_mask:0xf bank_mask:0xf
    s_nop 1
    v_add_f32_dpp v83, v83, v83 row_ror:1 row_mask:0xf bank_mask:0xf
    v_mov_b32_dpp v80, v28 row_newbcast:0 row_mask:0x5 bank_mask:0xf
    s_nop 1
    v_mov_b32_dpp v80, v28 row_newbcast:4 row_mask:0xa bank_mask:0xf
    v_sub_f32 v82, v80, v82
    v_mul_f32 v82, s59, v82
    v_exp_f32 v82, v82
    v_rcp_f32 v83, v83
    s_nop 0
    v_mul_f32 v28, v82, v83
    s_waitcnt vmcnt(15)
    buffer_load_dwordx4 a[20:23], v5, s[12:15], s45 offen nt
    v_permlane32_swap_b32 v96, v100
    v_permlane32_swap_b32 v97, v101
    v_permlane32_swap_b32 v98, v102
    v_permlane32_swap_b32 v99, v103
    v_add_f32_dpp v96, v100, v96 row_ror:8 row_mask:0xf bank_mask:0xf
    v_add_f32_dpp v97, v101, v97 row_ror:8 row_mask:0xf bank_mask:0xf
    v_add_f32_dpp v98, v102, v98 row_ror:8 row_mask:0xf bank_mask:0xf
    v_add_f32_dpp v99, v103, v99 row_ror:8 row_mask:0xf bank_mask:0xf
    v_mul_f32 v96, v96, v28
    v_mul_f32 v97, v97, v28
    v_mul_f32 v98, v98, v28
    v_mul_f32 v99, v99, v28
    s_lshl_b32 s59, s3, 9
    s_add_u32 s59, s59, 151552
    v_add_u32 v31, s59, v12
    s_mov_b64 exec, s[94:95]
    ds_write_b128 v31, v[96:99] offset:0
    s_mov_b64 exec, -1
    v_mfma_f32_16x16x16_bf16 v[104:107], v[58:59], a[116:117], v[104:107]
    v_mfma_f32_16x16x16_bf16 v[108:111], v[58:59], a[118:119], v[108:111]
    s_waitcnt vmcnt(14)
    buffer_load_dwordx4 a[24:27], v5, s[12:15], s46 offen nt
    v_mfma_f32_16x16x16_bf16 v[104:107], v[60:61], a[120:121], v[104:107]
    v_mfma_f32_16x16x16_bf16 v[108:111], v[60:61], a[122:123], v[108:111]
    v_alignbit_b32 v26, v6, v6, 18
    s_add_u32 m0, s57, 9216
    s_mov_b32 s60, 238592
    v_bitop3_b32 v26, v1, v26, s37 bitop3:0x78
    buffer_load_dwordx4 v26, s[28:31], s60 offen  lds
    s_waitcnt vmcnt(13)
    buffer_load_dwordx4 a[28:31], v5, s[12:15], s47 offen nt
    s_waitcnt lgkmcnt(0)
    v_mfma_f32_16x16x16_bf16 v[160:163], v[144:145], v[136:137], v[160:163]
    v_mfma_f32_16x16x16_bf16 v[164:167], v[146:147], v[136:137], v[164:167]
    v_mfma_f32_16x16x16_bf16 v[168:171], v[148:149], v[136:137], v[168:171]
    v_mfma_f32_16x16x16_bf16 v[172:175], v[150:151], v[136:137], v[172:175]
    ds_read_b64_tr_b16 v[152:153], v8 offset:2048
    ds_read_b64_tr_b16 v[154:155], v8 offset:2080
    ds_read_b64_tr_b16 v[156:157], v8 offset:2112
    ds_read_b64_tr_b16 v[158:159], v8 offset:2144
    v_mfma_f32_16x16x16_bf16 v[104:107], v[62:63], a[124:125], v[104:107]
    v_mfma_f32_16x16x16_bf16 v[108:111], v[62:63], a[126:127], v[108:111]
    s_waitcnt vmcnt(13)
    buffer_load_dwordx4 a[32:35], v5, s[12:15], s48 offen nt
    s_nop 5
    v_permlane32_swap_b32 v104, v108
    v_permlane32_swap_b32 v105, v109
    v_permlane32_swap_b32 v106, v110
    v_permlane32_swap_b32 v107, v111
    v_add_f32_dpp v104, v108, v104 row_ror:8 row_mask:0xf bank_mask:0xf
    v_add_f32_dpp v105, v109, v105 row_ror:8 row_mask:0xf bank_mask:0xf
    v_add_f32_dpp v106, v110, v106 row_ror:8 row_mask:0xf bank_mask:0xf
    v_add_f32_dpp v107, v111, v107 row_ror:8 row_mask:0xf bank_mask:0xf
    v_mul_f32 v104, v104, v28
    v_mul_f32 v105, v105, v28
    v_mul_f32 v106, v106, v28
    v_mul_f32 v107, v107, v28
    s_mov_b64 exec, s[94:95]
    ds_write_b128 v31, v[104:107] offset:2048
    s_mov_b64 exec, -1
    v_mfma_f32_16x16x16_bf16 v[96:99], v[32:33], a[0:1], 0
    v_mfma_f32_16x16x16_bf16 v[100:103], v[32:33], a[2:3], 0
    v_alignbit_b32 v26, v6, v6, 20
    s_add_u32 m0, s57, 10240
    s_mov_b32 s60, 239616
    v_bitop3_b32 v26, v1, v26, s37 bitop3:0x78
    buffer_load_dwordx4 v26, s[28:31], s60 offen  lds
    s_lshl4_add_u32 s59, s3, s4
    s_lshl_b32 s59, s59, 9
    s_add_u32 s59, s59, 917504
    v_bfe_u32 v68, v0, 4, 1
    v_lshlrev_b32 v68, 12, v68
    v_and_b32 v69, 15, v0
    v_lshlrev_b32 v69, 4, v69
    v_add3_u32 v68, v68, v69, s59
    buffer_load_dwordx3 v[64:66], v68, s[16:19], 0 offen sc1
    s_waitcnt vmcnt(13)
    buffer_load_dwordx4 a[36:39], v5, s[12:15], s49 offen nt
    v_mfma_f32_16x16x16_bf16 v[96:99], v[34:35], a[4:5], v[96:99]
    v_mfma_f32_16x16x16_bf16 v[100:103], v[34:35], a[6:7], v[100:103]
    s_waitcnt vmcnt(13)
    buffer_load_dwordx4 a[40:43], v5, s[12:15], s50 offen nt
    v_mfma_f32_16x16x16_bf16 v[96:99], v[36:37], a[8:9], v[96:99]
    v_mfma_f32_16x16x16_bf16 v[100:103], v[36:37], a[10:11], v[100:103]
    v_alignbit_b32 v26, v6, v6, 22
    s_add_u32 m0, s57, 11264
    s_mov_b32 s60, 240640
    v_bitop3_b32 v26, v1, v26, s37 bitop3:0x78
    buffer_load_dwordx4 v26, s[28:31], s60 offen  lds
    s_waitcnt vmcnt(13)
    buffer_load_dwordx4 a[44:47], v5, s[12:15], s51 offen nt
    v_mfma_f32_16x16x16_bf16 v[96:99], v[38:39], a[12:13], v[96:99]
    v_mfma_f32_16x16x16_bf16 v[100:103], v[38:39], a[14:15], v[100:103]
    s_waitcnt vmcnt(12)
    buffer_load_dwordx4 a[48:51], v5, s[12:15], s52 offen nt
    s_waitcnt lgkmcnt(0)
    v_mfma_f32_16x16x16_bf16 v[160:163], v[152:153], v[138:139], v[160:163]
    v_mfma_f32_16x16x16_bf16 v[164:167], v[154:155], v[138:139], v[164:167]
    v_mfma_f32_16x16x16_bf16 v[168:171], v[156:157], v[138:139], v[168:171]
    v_mfma_f32_16x16x16_bf16 v[172:175], v[158:159], v[138:139], v[172:175]
    ds_read_b64_tr_b16 v[144:145], v8 offset:4096
    ds_read_b64_tr_b16 v[146:147], v8 offset:4128
    ds_read_b64_tr_b16 v[148:149], v8 offset:4160
    ds_read_b64_tr_b16 v[150:151], v8 offset:4192
    v_mfma_f32_16x16x16_bf16 v[96:99], v[40:41], a[16:17], v[96:99]
    v_mfma_f32_16x16x16_bf16 v[100:103], v[40:41], a[18:19], v[100:103]
    v_alignbit_b32 v26, v6, v6, 24
    s_add_u32 m0, s57, 12288
    s_mov_b32 s60, 241664
    v_bitop3_b32 v26, v1, v26, s37 bitop3:0x78
    buffer_load_dwordx4 v26, s[28:31], s60 offen  lds
    s_waitcnt vmcnt(12)
    buffer_load_dwordx4 a[52:55], v5, s[12:15], s53 offen nt
    v_lshrrev_b32 v24, 4, v0
    v_and_b32 v25, 7, v0
    v_lshlrev_b32 v25, 4, v25
    v_lshl_add_u32 v24, v24, 7, v25
    v_add_u32 v25, s56, v24
    s_lshl_b32 s59, s3, 9
    v_add_u32 v24, s59, v24
    v_and_b32 v26, 15, v0
    v_and_b32 v27, 16, v0
    v_lshl_add_u32 v26, v26, 7, v27
    s_lshl_b32 s59, s3, 5
    v_add_u32 v26, s59, v26
    s_cmp_lt_u32 s93, 0
    s_cselect_b64 vcc, -1, 0
    v_cndmask_b32 v24, v26, v24, vcc
    v_add_u32 v180, 114688, v24
    s_waitcnt lgkmcnt(0)
    v_mfma_f32_16x16x16_bf16 v[160:163], v[144:145], v[140:141], v[160:163]
    v_mfma_f32_16x16x16_bf16 v[164:167], v[146:147], v[140:141], v[164:167]
    v_mfma_f32_16x16x16_bf16 v[168:171], v[148:149], v[140:141], v[168:171]
    v_mfma_f32_16x16x16_bf16 v[172:175], v[150:151], v[140:141], v[172:175]
    s_mov_b64 exec, s[94:95]
    s_nop 3
    ds_write_b128 v25, v[160:163] offset:0
    ds_write_b128 v25, v[164:167] offset:512
    ds_write_b128 v25, v[168:171] offset:1024
    ds_write_b128 v25, v[172:175] offset:1536
    s_mov_b64 exec, -1
    v_mfma_f32_16x16x16_bf16 v[96:99], v[42:43], a[20:21], v[96:99]
    v_mfma_f32_16x16x16_bf16 v[100:103], v[42:43], a[22:23], v[100:103]
    s_waitcnt vmcnt(12)
    buffer_load_dwordx4 a[56:59], v5, s[12:15], s54 offen nt
    v_mfma_f32_16x16x16_bf16 v[96:99], v[44:45], a[24:25], v[96:99]
    v_mfma_f32_16x16x16_bf16 v[100:103], v[44:45], a[26:27], v[100:103]
    v_alignbit_b32 v26, v6, v6, 26
    s_add_u32 m0, s57, 13312
    s_mov_b32 s60, 242688
    v_bitop3_b32 v26, v1, v26, s37 bitop3:0x78
    buffer_load_dwordx4 v26, s[28:31], s60 offen  lds
    s_waitcnt vmcnt(12)
    buffer_load_dwordx4 a[60:63], v5, s[12:15], s55 offen nt
    v_mfma_f32_16x16x16_bf16 v[96:99], v[46:47], a[28:29], v[96:99]
    v_mfma_f32_16x16x16_bf16 v[100:103], v[46:47], a[30:31], v[100:103]
    s_waitcnt vmcnt(12)
    s_add_u32 s59, s5, 4
    s_and_b32 s59, s59, 3
    s_lshl_b32 s59, s59, 7
    v_and_b32 v5, 0xfffffe7f, v5
    v_or_b32 v5, s59, v5
    buffer_load_dwordx4 a[64:67], v5, s[12:15], s40 offen nt
    v_mfma_f32_16x16x16_bf16 v[96:99], v[48:49], a[32:33], v[96:99]
    v_mfma_f32_16x16x16_bf16 v[100:103], v[48:49], a[34:35], v[100:103]
    s_waitcnt vmcnt(10)
    buffer_load_dwordx4 a[68:71], v5, s[12:15], s41 offen nt
    v_mfma_f32_16x16x16_bf16 v[96:99], v[50:51], a[36:37], v[96:99]
    v_mfma_f32_16x16x16_bf16 v[100:103], v[50:51], a[38:39], v[100:103]
L_grp_chk_1014:
    v_xor_b32 v64, s89, v64
    v_xor_b32 v66, s88, v66
    v_lshl_or_b32 v66, v64, 16, v66
    v_cmp_ne_u32 vcc, 0, v66
    s_cbranch_vccz L_grp_ok_1015
    buffer_load_dwordx3 v[64:66], v68, s[16:19], 0 offen sc1
    s_add_u32 s92, s92, 1
    s_cmp_gt_u32 s92, 1048576
    s_cbranch_scc1 L_grp_giveup_1016
    s_and_b32 s63, s92, 63
    s_cbranch_scc1 L_nowb_1017
    s_waitcnt vmcnt(0)
    buffer_wbl2 sc1
L_nowb_1017:
    s_waitcnt vmcnt(0)
    s_branch L_grp_chk_1014
L_grp_giveup_1016:
    s_waitcnt vmcnt(0)
L_grp_ok_1015:
    s_waitcnt vmcnt(10)
    buffer_load_dwordx4 a[72:75], v5, s[12:15], s42 offen nt
    v_mfma_f32_16x16x16_bf16 v[96:99], v[52:53], a[40:41], v[96:99]
    v_mfma_f32_16x16x16_bf16 v[100:103], v[52:53], a[42:43], v[100:103]
    s_waitcnt vmcnt(9)
    buffer_load_dwordx4 a[76:79], v5, s[12:15], s43 offen nt
    v_mfma_f32_16x16x16_bf16 v[96:99], v[54:55], a[44:45], v[96:99]
    v_mfma_f32_16x16x16_bf16 v[100:103], v[54:55], a[46:47], v[100:103]
    s_waitcnt vmcnt(9)
    buffer_load_dwordx4 a[80:83], v5, s[12:15], s44 offen nt
    v_mfma_f32_16x16x16_bf16 v[96:99], v[56:57], a[48:49], v[96:99]
    v_mfma_f32_16x16x16_bf16 v[100:103], v[56:57], a[50:51], v[100:103]
    s_waitcnt vmcnt(8)
    buffer_load_dwordx4 a[84:87], v5, s[12:15], s45 offen nt
    v_mfma_f32_16x16x16_bf16 v[96:99], v[58:59], a[52:53], v[96:99]
    v_mfma_f32_16x16x16_bf16 v[100:103], v[58:59], a[54:55], v[100:103]
    s_waitcnt vmcnt(8)
    buffer_load_dwordx4 a[88:91], v5, s[12:15], s46 offen nt
    v_mfma_f32_16x16x16_bf16 v[96:99], v[60:61], a[56:57], v[96:99]
    v_mfma_f32_16x16x16_bf16 v[100:103], v[60:61], a[58:59], v[100:103]
    s_waitcnt vmcnt(7)
    buffer_load_dwordx4 a[92:95], v5, s[12:15], s47 offen nt
    v_mfma_f32_16x16x16_bf16 v[96:99], v[62:63], a[60:61], v[96:99]
    v_mfma_f32_16x16x16_bf16 v[100:103], v[62:63], a[62:63], v[100:103]
    s_waitcnt vmcnt(7)
    buffer_load_dwordx4 a[96:99], v5, s[12:15], s48 offen nt
    s_nop 5
    v_permlane32_swap_b32 v96, v100
    v_permlane32_swap_b32 v97, v101
    v_permlane32_swap_b32 v98, v102
    v_permlane32_swap_b32 v99, v103
    v_add_f32_dpp v96, v100, v96 row_ror:8 row_mask:0xf bank_mask:0xf
    v_add_f32_dpp v97, v101, v97 row_ror:8 row_mask:0xf bank_mask:0xf
    v_add_f32_dpp v98, v102, v98 row_ror:8 row_mask:0xf bank_mask:0xf
    v_add_f32_dpp v99, v103, v99 row_ror:8 row_mask:0xf bank_mask:0xf
    v_mul_f32 v96, v96, v28
    v_mul_f32 v97, v97, v28
    v_mul_f32 v98, v98, v28
    v_mul_f32 v99, v99, v28
    s_mov_b64 exec, s[94:95]
    ds_write_b128 v31, v[96:99] offset:4096
    s_mov_b64 exec, -1
    v_mfma_f32_16x16x16_bf16 v[104:107], v[32:33], a[64:65], 0
    v_mfma_f32_16x16x16_bf16 v[108:111], v[32:33], a[66:67], 0
    s_waitcnt lgkmcnt(0)
    s_barrier
    s_lshl_b32 s59, s3, 11
    s_add_u32 s59, s59, 151552
    v_add_u32 v24, s59, v12
    ds_read_b128 v[80:83], v24 offset:0
    ds_read_b128 v[84:87], v24 offset:512
    ds_read_b128 v[88:91], v24 offset:1024
    ds_read_b128 v[92:95], v24 offset:1536
    s_waitcnt vmcnt(7)
    buffer_load_dwordx4 a[100:103], v5, s[12:15], s49 offen nt
    v_mfma_f32_16x16x16_bf16 v[104:107], v[34:35], a[68:69], v[104:107]
    v_mfma_f32_16x16x16_bf16 v[108:111], v[34:35], a[70:71], v[108:111]
    s_add_u32 s59, s5, s3
    s_add_u32 s59, s59, 1
    s_and_b32 s59, s59, 3
    s_lshl_b32 s59, s59, 3
    s_and_b32 s60, s2, 0xe7
    s_or_b32 s59, s59, s60
    s_mul_i32 s59, s59, 1536
    s_lshl_b32 s60, s3, 9
    s_add_u32 s60, s60, 524288
    s_cmp_eq_u32 s3, 3
    s_cselect_b32 s60, 1073741824, s60
    s_add_u32 s59, s59, s60
    s_mul_i32 s61, s2, 1536
    s_add_u32 s60, s60, s61
    v_and_b32 v30, 48, v0
    v_and_b32 v26, 7, v0
    v_lshlrev_b32 v26, 4, v26
    v_lshl_add_u32 v30, v30, 3, v26
    v_add_u32 v25, s59, v30
    v_mov_b32 v26, 1073741824
    v_cndmask_b32 v25, v26, v25, s[94:95]
    v_add_u32 v30, s60, v30
    v_and_b32 v26, 3, v0
    v_lshlrev_b32 v26, 3, v26
    v_lshrrev_b32 v103, v26, s88
    v_bfe_u32 v100, v103, 0, 2
    v_bfe_u32 v101, v103, 2, 2
    v_bfe_u32 v102, v103, 4, 2
    v_bfe_u32 v103, v103, 6, 2
    s_waitcnt lgkmcnt(0)
    v_add_f32 v80, v80, v84
    v_add_f32 v88, v88, v92
    v_add_f32 v81, v81, v85
    v_add_f32 v89, v89, v93
    v_add_f32 v82, v82, v86
    v_add_f32 v90, v90, v94
    v_add_f32 v83, v83, v87
    v_add_f32 v91, v91, v95
    v_add_f32 v84, v80, v88
    v_add_f32 v85, v81, v89
    v_add_f32 v86, v82, v90
    v_add_f32 v87, v83, v91
    v_bfi_b32 v84, 3, v100, v84
    v_bfi_b32 v85, 3, v101, v85
    v_bfi_b32 v86, 3, v102, v86
    v_bfi_b32 v87, 3, v103, v87
    buffer_store_dwordx4 v[84:87], v25, s[16:19], 0 offen
    s_cmp_eq_u32 s3, 3
    s_cselect_b32 s59, 0, 3
    v_and_b32 v100, s59, v100
    v_and_b32 v101, s59, v101
    v_and_b32 v102, s59, v102
    v_and_b32 v103, s59, v103
    s_waitcnt vmcnt(8)
    buffer_load_dwordx4 a[104:107], v5, s[12:15], s50 offen nt
    v_mfma_f32_16x16x16_bf16 v[104:107], v[36:37], a[72:73], v[104:107]
    v_mfma_f32_16x16x16_bf16 v[108:111], v[36:37], a[74:75], v[108:111]
    ds_read_b128 v[160:163], v180 offset:0
    ds_read_b128 v[164:167], v180 offset:8448
    ds_read_b128 v[168:171], v180 offset:16896
    ds_read_b128 v[172:175], v180 offset:25344
    s_lshl_b32 s60, s24, 8
    s_mul_i32 s61, s3, 14336
    s_add_u32 s60, s60, s61
    s_add_u32 s60, s60, 979456
    s_cmp_lg_u32 s22, 0
    s_cselect_b32 s60, s60, 1073741824
    v_lshrrev_b32 v24, 4, v0
    v_mul_u32_u24 v24, 7168, v24
    v_and_b32 v25, 15, v0
    v_lshl_add_u32 v24, v25, 4, v24
    v_add_u32 v24, s60, v24
    v_mov_b32 v26, 1073741824
    v_cmp_gt_u32 vcc, 32, v0
    s_nop 1
    v_cndmask_b32 v25, v26, v24, vcc
    s_waitcnt lgkmcnt(0)
    v_add_f32 v160, v160, v164
    v_add_f32 v168, v168, v172
    v_add_f32 v161, v161, v165
    v_add_f32 v169, v169, v173
    v_add_f32 v162, v162, v166
    v_add_f32 v170, v170, v174
    v_add_f32 v163, v163, v167
    v_add_f32 v171, v171, v175
    v_add_f32 v160, v160, v168
    v_add_f32 v161, v161, v169
    v_add_f32 v162, v162, v170
    v_add_f32 v163, v163, v171
    v_cvt_pk_bf16_f32 v160, 0, v160
    v_cvt_pk_bf16_f32 v161, 0, v161
    v_cvt_pk_bf16_f32 v162, 0, v162
    v_cvt_pk_bf16_f32 v163, 0, v163
    v_or_b32 v160, s89, v160
    v_or_b32 v161, s1, v161
    v_or_b32 v162, s89, v162
    v_or_b32 v163, s1, v163
    buffer_store_dwordx4 v[160:163], v25, s[16:19], 0 offen sc1
    s_add_u32 s59, s36, 0
    v_xad_u32 v27, v2, s59, v9
    ds_read_b64_tr_b16 a[136:137], v27 offset:0
    ds_read_b64_tr_b16 a[138:139], v27 offset:3584
    ds_read_b64_tr_b16 a[140:141], v27 offset:28672
    ds_read_b64_tr_b16 a[142:143], v27 offset:32256
    s_add_u32 s59, s36, 32
    v_xad_u32 v27, v2, s59, v9
    ds_read_b64_tr_b16 a[152:153], v27 offset:0
    ds_read_b64_tr_b16 a[154:155], v27 offset:3584
    ds_read_b64_tr_b16 a[156:157], v27 offset:28672
    ds_read_b64_tr_b16 a[158:159], v27 offset:32256
    s_add_u32 s59, s36, 64
    v_xad_u32 v27, v2, s59, v9
    ds_read_b64_tr_b16 a[168:169], v27 offset:0
    ds_read_b64_tr_b16 a[170:171], v27 offset:3584
    ds_read_b64_tr_b16 a[172:173], v27 offset:28672
    ds_read_b64_tr_b16 a[174:175], v27 offset:32256
    s_add_u32 s59, s36, 96
    v_xad_u32 v27, v2, s59, v9
    ds_read_b64_tr_b16 a[184:185], v27 offset:0
    ds_read_b64_tr_b16 a[186:187], v27 offset:3584
    ds_read_b64_tr_b16 a[188:189], v27 offset:28672
    ds_read_b64_tr_b16 a[190:191], v27 offset:32256
    s_waitcnt vmcnt(9)
    buffer_load_dwordx4 a[108:111], v5, s[12:15], s51 offen nt
    v_mfma_f32_16x16x16_bf16 v[104:107], v[38:39], a[76:77], v[104:107]
    v_mfma_f32_16x16x16_bf16 v[108:111], v[38:39], a[78:79], v[108:111]
    s_add_u32 s59, s36, 128
    v_xad_u32 v27, v2, s59, v9
    ds_read_b64_tr_b16 a[200:201], v27 offset:0
    ds_read_b64_tr_b16 a[202:203], v27 offset:3584
    ds_read_b64_tr_b16 a[204:205], v27 offset:28672
    ds_read_b64_tr_b16 a[206:207], v27 offset:32256
    s_add_u32 s59, s36, 160
    v_xad_u32 v27, v2, s59, v9
    ds_read_b64_tr_b16 a[216:217], v27 offset:0
    ds_read_b64_tr_b16 a[218:219], v27 offset:3584
    ds_read_b64_tr_b16 a[220:221], v27 offset:28672
    ds_read_b64_tr_b16 a[222:223], v27 offset:32256
    s_add_u32 s59, s36, 192
    v_xad_u32 v27, v2, s59, v9
    ds_read_b64_tr_b16 a[232:233], v27 offset:0
    ds_read_b64_tr_b16 a[234:235], v27 offset:3584
    ds_read_b64_tr_b16 a[236:237], v27 offset:28672
    ds_read_b64_tr_b16 a[238:239], v27 offset:32256
    buffer_load_dwordx4 v[96:99], v30, s[16:19], 0 offen sc1
    s_waitcnt vmcnt(10)
    buffer_load_dwordx4 a[112:115], v5, s[12:15], s52 offen nt
    v_mfma_f32_16x16x16_bf16 v[104:107], v[40:41], a[80:81], v[104:107]
    v_mfma_f32_16x16x16_bf16 v[108:111], v[40:41], a[82:83], v[108:111]
    s_waitcnt vmcnt(10)
    buffer_load_dwordx4 a[116:119], v5, s[12:15], s53 offen nt
    v_mfma_f32_16x16x16_bf16 v[104:107], v[42:43], a[84:85], v[104:107]
    v_mfma_f32_16x16x16_bf16 v[108:111], v[42:43], a[86:87], v[108:111]
    s_waitcnt vmcnt(10)
    buffer_load_dwordx4 a[120:123], v5, s[12:15], s54 offen nt
    v_mfma_f32_16x16x16_bf16 v[104:107], v[44:45], a[88:89], v[104:107]
    v_mfma_f32_16x16x16_bf16 v[108:111], v[44:45], a[90:91], v[108:111]
    s_waitcnt vmcnt(10)
    buffer_load_dwordx4 a[124:127], v5, s[12:15], s55 offen nt
    v_mfma_f32_16x16x16_bf16 v[104:107], v[46:47], a[92:93], v[104:107]
    v_mfma_f32_16x16x16_bf16 v[108:111], v[46:47], a[94:95], v[108:111]
    s_lshl2_add_u32 s59, s4, s5
    s_lshl_b32 s59, s59, 8
    s_add_u32 s48, s59, 1048576
    s_lshl_b32 s59, s7, 8
    s_add_u32 s49, s59, 1310720
    s_lshl_b32 s59, s3, 9
    s_add_u32 s59, s59, 157696
    v_add_u32 v31, s59, v12
    s_waitcnt vmcnt(10)
    v_mfma_f32_16x16x16_bf16 v[104:107], v[48:49], a[96:97], v[104:107]
    v_mfma_f32_16x16x16_bf16 v[108:111], v[48:49], a[98:99], v[108:111]
    s_waitcnt vmcnt(9)
    v_mfma_f32_16x16x16_bf16 v[104:107], v[50:51], a[100:101], v[104:107]
    v_mfma_f32_16x16x16_bf16 v[108:111], v[50:51], a[102:103], v[108:111]
    s_waitcnt vmcnt(7)
    v_mfma_f32_16x16x16_bf16 v[104:107], v[52:53], a[104:105], v[104:107]
    v_mfma_f32_16x16x16_bf16 v[108:111], v[52:53], a[106:107], v[108:111]
    s_waitcnt vmcnt(5)
    v_mfma_f32_16x16x16_bf16 v[104:107], v[54:55], a[108:109], v[104:107]
    v_mfma_f32_16x16x16_bf16 v[108:111], v[54:55], a[110:111], v[108:111]
    s_waitcnt vmcnt(4)
L_of_chk_1018:
    v_xor_b32 v96, v100, v96
    v_xor_b32 v97, v101, v97
    v_xor_b32 v98, v102, v98
    v_xor_b32 v99, v103, v99
    v_or3_b32 v24, v96, v97, v98
    v_or_b32 v24, v24, v99
    v_and_b32 v24, 3, v24
    v_cmp_ne_u32 vcc, 0, v24
    s_cbranch_vccz L_of_ok_1019
    buffer_load_dwordx4 v[96:99], v30, s[16:19], 0 offen sc1
    s_add_u32 s92, s92, 1
    s_cmp_gt_u32 s92, 1048576
    s_cbranch_scc1 L_of_giveup_1020
    s_and_b32 s63, s92, 63
    s_cbranch_scc1 L_nowb_1021
    s_waitcnt vmcnt(0)
    buffer_wbl2 sc1
L_nowb_1021:
    s_waitcnt vmcnt(0)
    s_branch L_of_chk_1018
L_of_giveup_1020:
    s_waitcnt vmcnt(0)
L_of_ok_1019:
    s_waitcnt vmcnt(3)
    v_mfma_f32_16x16x16_bf16 v[104:107], v[56:57], a[112:113], v[104:107]
    v_mfma_f32_16x16x16_bf16 v[108:111], v[56:57], a[114:115], v[108:111]
    s_waitcnt vmcnt(2)
    v_mfma_f32_16x16x16_bf16 v[104:107], v[58:59], a[116:117], v[104:107]
    v_mfma_f32_16x16x16_bf16 v[108:111], v[58:59], a[118:119], v[108:111]
    s_waitcnt vmcnt(1)
    v_mfma_f32_16x16x16_bf16 v[104:107], v[60:61], a[120:121], v[104:107]
    v_mfma_f32_16x16x16_bf16 v[108:111], v[60:61], a[122:123], v[108:111]
    s_waitcnt vmcnt(0)
    v_mfma_f32_16x16x16_bf16 v[104:107], v[62:63], a[124:125], v[104:107]
    v_mfma_f32_16x16x16_bf16 v[108:111], v[62:63], a[126:127], v[108:111]
    s_nop 7
    v_permlane32_swap_b32 v104, v108
    v_permlane32_swap_b32 v105, v109
    v_permlane32_swap_b32 v106, v110
    v_permlane32_swap_b32 v107, v111
    v_add_f32_dpp v104, v108, v104 row_ror:8 row_mask:0xf bank_mask:0xf
    v_add_f32_dpp v105, v109, v105 row_ror:8 row_mask:0xf bank_mask:0xf
    v_add_f32_dpp v106, v110, v106 row_ror:8 row_mask:0xf bank_mask:0xf
    v_add_f32_dpp v107, v111, v107 row_ror:8 row_mask:0xf bank_mask:0xf
    v_fma_f32 v104, v104, v28, v96
    v_fma_f32 v105, v105, v28, v97
    v_fma_f32 v106, v106, v28, v98
    v_fma_f32 v107, v107, v28, v99
    s_mov_b64 exec, s[94:95]
    ds_write_b128 v31, v[104:107]
    s_mov_b64 exec, -1
    v_mov_b64 v[32:33], 0
    v_mov_b64 v[36:37], 0
    v_mov_b64 v[40:41], 0
    v_mov_b64 v[44:45], 0
    v_mov_b64 v[48:49], 0
    v_mov_b64 v[52:53], 0
    v_mov_b64 v[56:57], 0
    s_waitcnt lgkmcnt(0)
    s_barrier
    ds_read2st64_b64 v[96:99], v15 offset0:0 offset1:1
    ds_read2st64_b64 v[100:103], v15 offset0:2 offset1:3
    s_waitcnt lgkmcnt(1)
    v_pk_add_f32 v[96:97], v[96:97], v[98:99]
    s_waitcnt lgkmcnt(0)
    v_pk_add_f32 v[100:101], v[100:101], v[102:103]
    v_pk_add_f32 v[96:97], v[96:97], v[100:101]
    v_cvt_pk_bf16_f32 v112, v96, v97
    s_nop 1
    v_mov_b32_dpp v113, v112 row_ror:14 row_mask:0xf bank_mask:0xf
    v_mov_b32_dpp v114, v112 row_ror:12 row_mask:0xf bank_mask:0xf
    v_mov_b32_dpp v115, v112 row_ror:10 row_mask:0xf bank_mask:0xf
    s_nop 1
    v_smfmac_f32_16x16x64_bf16 v[32:35], v[112:115], a[128:135], v10
    v_mov_b32_dpp v116, v112 row_ror:8 row_mask:0xf bank_mask:0xf
    v_smfmac_f32_16x16x64_bf16 v[36:39], v[112:115], a[144:151], v10
    v_mov_b32_dpp v117, v112 row_ror:6 row_mask:0xf bank_mask:0xf
    v_smfmac_f32_16x16x64_bf16 v[40:43], v[112:115], a[160:167], v10
    v_mov_b32_dpp v118, v112 row_ror:4 row_mask:0xf bank_mask:0xf
    v_smfmac_f32_16x16x64_bf16 v[44:47], v[112:115], a[176:183], v10
    v_mov_b32_dpp v119, v112 row_ror:2 row_mask:0xf bank_mask:0xf
    v_smfmac_f32_16x16x64_bf16 v[48:51], v[112:115], a[192:199], v10
    v_smfmac_f32_16x16x64_bf16 v[52:55], v[112:115], a[208:215], v10
    v_smfmac_f32_16x16x64_bf16 v[56:59], v[112:115], a[224:231], v10
    v_smfmac_f32_16x16x64_bf16 v[32:35], v[116:119], a[136:143], v10
    v_smfmac_f32_16x16x64_bf16 v[36:39], v[116:119], a[152:159], v10
    v_smfmac_f32_16x16x64_bf16 v[40:43], v[116:119], a[168:175], v10
    v_smfmac_f32_16x16x64_bf16 v[44:47], v[116:119], a[184:191], v10
    v_smfmac_f32_16x16x64_bf16 v[48:51], v[116:119], a[200:207], v10
    v_smfmac_f32_16x16x64_bf16 v[52:55], v[116:119], a[216:223], v10
    v_smfmac_f32_16x16x64_bf16 v[56:59], v[116:119], a[232:239], v10
    s_mov_b64 exec, 0xffff
    s_nop 0
    v_add_f32 v32, v32, v33
    v_add_f32 v36, v36, v37
    v_add_f32 v40, v40, v41
    v_cvt_pk_bf16_f32 v92, 0, v32
    v_add_f32 v44, v44, v45
    v_cvt_pk_bf16_f32 v93, v36, v40
    v_add_f32 v48, v48, v49
    v_or_b32 v92, v11, v92
    v_add_f32 v52, v52, v53
    v_cvt_pk_bf16_f32 v94, v44, v48
    v_add_f32 v56, v56, v57
    v_cvt_pk_bf16_f32 v95, v52, v56
    buffer_store_dwordx4 v[92:95], v13, s[16:19], s48 offen sc1
    s_mov_b64 exec, -1
    s_cmp_lt_u32 s93, 25
    s_cbranch_scc1 L_no2nd_1022
    s_lshl_b32 s59, s24, 7
    s_sub_u32 s20, s20, s59
    s_subb_u32 s21, s21, 0
    s_add_u32 s24, s93, 10
    s_lshl_b32 s59, s24, 7
    s_add_u32 s20, s20, s59
    s_addc_u32 s21, s21, 0
    s_mov_b32 s22, 596864
    v_lshrrev_b32 v24, 2, v0
    v_and_b32 v25, 3, v0
    v_lshlrev_b32 v25, 3, v25
    v_lshl_add_u32 v24, v24, 7, v25
    v_add_u32 v8, s58, v24
    s_add_u32 m0, s58, 0
    s_mov_b32 s60, 0
    buffer_load_dwordx4 v7, s[20:23], s60 offen nt lds
    s_add_u32 m0, s58, 1024
    s_mov_b32 s60, 43008
    buffer_load_dwordx4 v7, s[20:23], s60 offen nt lds
    s_add_u32 m0, s58, 2048
    s_mov_b32 s60, 86016
    buffer_load_dwordx4 v7, s[20:23], s60 offen nt lds
    s_add_u32 m0, s58, 3072
    s_mov_b32 s60, 129024
    buffer_load_dwordx4 v7, s[20:23], s60 offen nt lds
    s_add_u32 m0, s58, 4096
    s_mov_b32 s60, 172032
    buffer_load_dwordx4 v7, s[20:23], s60 offen nt lds
    s_add_u32 m0, s58, 5120
    s_mov_b32 s60, 215040
    buffer_load_dwordx4 v7, s[20:23], s60 offen nt lds
    s_add_u32 m0, s58, 6144
    s_mov_b32 s60, 258048
    buffer_load_dwordx4 v7, s[20:23], s60 offen nt lds
    s_add_u32 m0, s58, 7168
    s_mov_b32 s60, 301056
    buffer_load_dwordx4 v7, s[20:23], s60 offen nt lds
    s_add_u32 m0, s58, 8192
    s_mov_b32 s60, 344064
    buffer_load_dwordx4 v7, s[20:23], s60 offen nt lds
    s_add_u32 m0, s58, 9216
    s_mov_b32 s60, 387072
    buffer_load_dwordx4 v7, s[20:23], s60 offen nt lds
    s_add_u32 m0, s58, 10240
    s_mov_b32 s60, 430080
    buffer_load_dwordx4 v7, s[20:23], s60 offen nt lds
    s_add_u32 m0, s58, 11264
    s_mov_b32 s60, 473088
    buffer_load_dwordx4 v7, s[20:23], s60 offen nt lds
    s_add_u32 m0, s58, 12288
    s_mov_b32 s60, 516096
    buffer_load_dwordx4 v7, s[20:23], s60 offen nt lds
    s_add_u32 m0, s58, 13312
    s_mov_b32 s60, 559104
    buffer_load_dwordx4 v7, s[20:23], s60 offen nt lds
    s_waitcnt vmcnt(12)
    ds_read_b64_tr_b16 v[144:145], v8 offset:0
    ds_read_b64_tr_b16 v[146:147], v8 offset:32
    ds_read_b64_tr_b16 v[148:149], v8 offset:64
    ds_read_b64_tr_b16 v[150:151], v8 offset:96
    s_waitcnt vmcnt(10)
    s_waitcnt lgkmcnt(0)
    v_mfma_f32_16x16x16_bf16 v[160:163], v[144:145], v[128:129], 0
    v_mfma_f32_16x16x16_bf16 v[164:167], v[146:147], v[128:129], 0
    v_mfma_f32_16x16x16_bf16 v[168:171], v[148:149], v[128:129], 0
    v_mfma_f32_16x16x16_bf16 v[172:175], v[150:151], v[128:129], 0
    ds_read_b64_tr_b16 v[152:153], v8 offset:2048
    ds_read_b64_tr_b16 v[154:155], v8 offset:2080
    ds_read_b64_tr_b16 v[156:157], v8 offset:2112
    ds_read_b64_tr_b16 v[158:159], v8 offset:2144
    s_waitcnt vmcnt(8)
    s_waitcnt lgkmcnt(0)
    v_mfma_f32_16x16x16_bf16 v[160:163], v[152:153], v[130:131], v[160:163]
    v_mfma_f32_16x16x16_bf16 v[164:167], v[154:155], v[130:131], v[164:167]
    v_mfma_f32_16x16x16_bf16 v[168:171], v[156:157], v[130:131], v[168:171]
    v_mfma_f32_16x16x16_bf16 v[172:175], v[158:159], v[130:131], v[172:175]
    ds_read_b64_tr_b16 v[144:145], v8 offset:4096
    ds_read_b64_tr_b16 v[146:147], v8 offset:4128
    ds_read_b64_tr_b16 v[148:149], v8 offset:4160
    ds_read_b64_tr_b16 v[150:151], v8 offset:4192
    s_waitcnt vmcnt(6)
    s_waitcnt lgkmcnt(0)
    v_mfma_f32_16x16x16_bf16 v[160:163], v[144:145], v[132:133], v[160:163]
    v_mfma_f32_16x16x16_bf16 v[164:167], v[146:147], v[132:133], v[164:167]
    v_mfma_f32_16x16x16_bf16 v[168:171], v[148:149], v[132:133], v[168:171]
    v_mfma_f32_16x16x16_bf16 v[172:175], v[150:151], v[132:133], v[172:175]
    ds_read_b64_tr_b16 v[152:153], v8 offset:6144
    ds_read_b64_tr_b16 v[154:155], v8 offset:6176
    ds_read_b64_tr_b16 v[156:157], v8 offset:6208
    ds_read_b64_tr_b16 v[158:159], v8 offset:6240
    s_waitcnt vmcnt(4)
    s_waitcnt lgkmcnt(0)
    v_mfma_f32_16x16x16_bf16 v[160:163], v[152:153], v[134:135], v[160:163]
    v_mfma_f32_16x16x16_bf16 v[164:167], v[154:155], v[134:135], v[164:167]
    v_mfma_f32_16x16x16_bf16 v[168:171], v[156:157], v[134:135], v[168:171]
    v_mfma_f32_16x16x16_bf16 v[172:175], v[158:159], v[134:135], v[172:175]
    ds_read_b64_tr_b16 v[144:145], v8 offset:8192
    ds_read_b64_tr_b16 v[146:147], v8 offset:8224
    ds_read_b64_tr_b16 v[148:149], v8 offset:8256
    ds_read_b64_tr_b16 v[150:151], v8 offset:8288
    s_waitcnt vmcnt(2)
    s_waitcnt lgkmcnt(0)
    v_mfma_f32_16x16x16_bf16 v[160:163], v[144:145], v[136:137], v[160:163]
    v_mfma_f32_16x16x16_bf16 v[164:167], v[146:147], v[136:137], v[164:167]
    v_mfma_f32_16x16x16_bf16 v[168:171], v[148:149], v[136:137], v[168:171]
    v_mfma_f32_16x16x16_bf16 v[172:175], v[150:151], v[136:137], v[172:175]
    ds_read_b64_tr_b16 v[152:153], v8 offset:10240
    ds_read_b64_tr_b16 v[154:155], v8 offset:10272
    ds_read_b64_tr_b16 v[156:157], v8 offset:10304
    ds_read_b64_tr_b16 v[158:159], v8 offset:10336
    s_waitcnt vmcnt(0)
    s_waitcnt lgkmcnt(0)
    v_mfma_f32_16x16x16_bf16 v[160:163], v[152:153], v[138:139], v[160:163]
    v_mfma_f32_16x16x16_bf16 v[164:167], v[154:155], v[138:139], v[164:167]
    v_mfma_f32_16x16x16_bf16 v[168:171], v[156:157], v[138:139], v[168:171]
    v_mfma_f32_16x16x16_bf16 v[172:175], v[158:159], v[138:139], v[172:175]
    ds_read_b64_tr_b16 v[144:145], v8 offset:12288
    ds_read_b64_tr_b16 v[146:147], v8 offset:12320
    ds_read_b64_tr_b16 v[148:149], v8 offset:12352
    ds_read_b64_tr_b16 v[150:151], v8 offset:12384
    v_lshrrev_b32 v24, 4, v0
    v_and_b32 v25, 7, v0
    v_lshlrev_b32 v25, 4, v25
    v_lshl_add_u32 v24, v24, 7, v25
    v_add_u32 v25, s58, v24
    s_lshl_b32 s59, s3, 9
    v_add_u32 v24, s59, v24
    v_and_b32 v26, 15, v0
    v_and_b32 v27, 16, v0
    v_lshl_add_u32 v26, v26, 7, v27
    s_lshl_b32 s59, s3, 5
    v_add_u32 v26, s59, v26
    s_cmp_lt_u32 s93, 14
    s_cselect_b64 vcc, -1, 0
    v_cndmask_b32 v24, v26, v24, vcc
    v_add_u32 v180, 57344, v24
    s_waitcnt lgkmcnt(0)
    v_mfma_f32_16x16x16_bf16 v[160:163], v[144:145], v[140:141], v[160:163]
    v_mfma_f32_16x16x16_bf16 v[164:167], v[146:147], v[140:141], v[164:167]
    v_mfma_f32_16x16x16_bf16 v[168:171], v[148:149], v[140:141], v[168:171]
    v_mfma_f32_16x16x16_bf16 v[172:175], v[150:151], v[140:141], v[172:175]
    s_mov_b64 exec, s[94:95]
    s_nop 3
    ds_write_b128 v25, v[160:163] offset:0
    ds_write_b128 v25, v[164:167] offset:512
    ds_write_b128 v25, v[168:171] offset:1024
    ds_write_b128 v25, v[172:175] offset:1536
    s_mov_b64 exec, -1
    s_waitcnt lgkmcnt(0)
    s_barrier
    ds_read_b128 v[160:163], v180 offset:0
    ds_read_b128 v[164:167], v180 offset:14336
    ds_read_b128 v[168:171], v180 offset:28672
    ds_read_b128 v[172:175], v180 offset:43008
    s_lshl_b32 s60, s24, 8
    s_mul_i32 s61, s3, 14336
    s_add_u32 s60, s60, s61
    s_add_u32 s60, s60, 979456
    v_lshrrev_b32 v24, 4, v0
    v_mul_u32_u24 v24, 7168, v24
    v_and_b32 v25, 15, v0
    v_lshl_add_u32 v24, v25, 4, v24
    v_add_u32 v24, s60, v24
    v_mov_b32 v26, 1073741824
    v_cmp_gt_u32 vcc, 32, v0
    s_nop 1
    v_cndmask_b32 v25, v26, v24, vcc
    s_waitcnt lgkmcnt(0)
    v_add_f32 v160, v160, v164
    v_add_f32 v168, v168, v172
    v_add_f32 v161, v161, v165
    v_add_f32 v169, v169, v173
    v_add_f32 v162, v162, v166
    v_add_f32 v170, v170, v174
    v_add_f32 v163, v163, v167
    v_add_f32 v171, v171, v175
    v_add_f32 v160, v160, v168
    v_add_f32 v161, v161, v169
    v_add_f32 v162, v162, v170
    v_add_f32 v163, v163, v171
    v_cvt_pk_bf16_f32 v160, 0, v160
    v_cvt_pk_bf16_f32 v161, 0, v161
    v_cvt_pk_bf16_f32 v162, 0, v162
    v_cvt_pk_bf16_f32 v163, 0, v163
    v_or_b32 v160, s89, v160
    v_or_b32 v161, s1, v161
    v_or_b32 v162, s89, v162
    v_or_b32 v163, s1, v163
    buffer_store_dwordx4 v[160:163], v25, s[16:19], 0 offen sc1
    s_branch L_join_1023
L_no2nd_1022:
    s_waitcnt vmcnt(0)
L_join_1023:
    s_mov_b32 s40, 1048576
    s_mov_b32 s41, 1052672
    buffer_load_dwordx4 v[64:67], v14, s[16:19], s40 offen sc1
    buffer_load_dwordx4 v[68:71], v14, s[16:19], s41 offen sc1
    buffer_load_dword v16, v4, s[16:19], 0 offen offset:0 sc1
    v_mov_b64 v[108:109], 0
    s_waitcnt vmcnt(0)
L_p_chk_1024:
    v_xor_b32 v24, v11, v64
    v_bitop3_b32 v24, v24, v68, v11 bitop3:0xf6
    v_bitop3_b32 v24, v24, v16, v29 bitop3:0xf6
    v_cmp_ne_u16 vcc, 0, v24
    s_cbranch_vccz L_p_ok_1025
    buffer_load_dwordx4 v[64:67], v14, s[16:19], s40 offen sc1
    buffer_load_dwordx4 v[68:71], v14, s[16:19], s41 offen sc1
    buffer_load_dword v16, v4, s[16:19], 0 offen offset:0 sc1
    s_add_u32 s92, s92, 1
    s_cmp_gt_u32 s92, 1048576
    s_cbranch_scc1 L_p_giveup_1026
    s_and_b32 s63, s92, 63
    s_cbranch_scc1 L_nowb_1027
    s_waitcnt vmcnt(0)
    buffer_wbl2 sc1
L_nowb_1027:
    s_waitcnt vmcnt(0)
    s_branch L_p_chk_1024
L_p_giveup_1026:
    s_waitcnt vmcnt(0)
L_p_ok_1025:
    v_smfmac_f32_16x16x64_bf16 v[108:111], v[124:127], v[64:71], v10 abid:1
    v_and_b32 v16, 0xffff0000, v16
    s_nop 6
    v_add_f32_dpp v110, v108, v108 row_ror:8 row_mask:0xf bank_mask:0x3
    s_nop 1
    v_add_f32_dpp v110, v109, v109 row_ror:8 row_mask:0xf bank_mask:0xc
    s_nop 1
    v_add_f32_dpp v108, v110, v110 row_ror:4 row_mask:0xf bank_mask:0xf
    v_and_b32 v18, 0xffff0000, v18
    v_cvt_pk_bf16_f32 v108, 0, v108
    v_mul_f32 v108, v108, v16
    v_cvt_pk_bf16_f32 v108, 0, v108
    v_add_f32 v18, v108, v18
    v_cvt_pk_bf16_f32 v18, 0, v18
    s_mov_b32 s40, 1310720
    s_mov_b32 s41, 1314816
    buffer_load_dwordx4 v[64:67], v14, s[16:19], s40 offen sc1
    buffer_load_dwordx4 v[68:71], v22, s[16:19], s41 offen sc1
    buffer_load_dword v16, v19, s[16:19], 0 offen offset:0 sc1
    v_mov_b64 v[108:109], 0
    s_waitcnt vmcnt(0)
L_f_chk_1028:
    v_xor_b32 v24, v11, v64
    v_bitop3_b32 v24, v24, v68, v23 bitop3:0xf6
    v_bitop3_b32 v24, v24, v16, v29 bitop3:0xf6
    v_cmp_ne_u16 vcc, 0, v24
    s_cbranch_vccz L_f_ok_1029
    buffer_load_dwordx4 v[64:67], v14, s[16:19], s40 offen sc1
    buffer_load_dwordx4 v[68:71], v22, s[16:19], s41 offen sc1
    buffer_load_dword v16, v19, s[16:19], 0 offen offset:0 sc1
    s_add_u32 s92, s92, 1
    s_cmp_gt_u32 s92, 1048576
    s_cbranch_scc1 L_f_giveup_1030
    s_and_b32 s63, s92, 63
    s_cbranch_scc1 L_nowb_1031
    s_waitcnt vmcnt(0)
    buffer_wbl2 sc1
L_nowb_1031:
    s_waitcnt vmcnt(0)
    s_branch L_f_chk_1028
L_f_giveup_1030:
    s_waitcnt vmcnt(0)
L_f_ok_1029:
    v_smfmac_f32_16x16x64_bf16 v[108:111], v[124:127], v[64:71], v10 abid:1
    v_and_b32 v16, 0xffff0000, v16
    s_nop 6
    v_add_f32_dpp v110, v108, v108 row_ror:8 row_mask:0xf bank_mask:0x3
    s_nop 1
    v_add_f32_dpp v110, v109, v109 row_ror:8 row_mask:0xf bank_mask:0xc
    s_nop 1
    v_add_f32_dpp v108, v110, v110 row_ror:4 row_mask:0xf bank_mask:0xf
    s_mov_b64 exec, s[100:101]
    v_fma_f32 v108, v108, v16, v18
    v_cvt_pk_bf16_f32 v108, v108, v108
    global_store_short v3, v108, s[86:87]
    s_mov_b64 exec, -1
    s_endpgm
L_end:
    s_endpgm
L_codeend:
.section .rodata,"a"
.p2align 6
.amdhsa_kernel adaLN_cond__sliding_block_cached__glu_gated_swiglu__decode_kernel
  .amdhsa_next_free_vgpr 512
  .amdhsa_next_free_sgpr 102
  .amdhsa_accum_offset 256
  .amdhsa_group_segment_fixed_size 0
  .amdhsa_kernarg_size 112
  .amdhsa_user_sgpr_count 2
  .amdhsa_user_sgpr_kernarg_segment_ptr 1
  .amdhsa_system_sgpr_workgroup_id_x 1
  .amdhsa_float_denorm_mode_32 3
.end_amdhsa_kernel
```
